```python
import torch

def _softmax(x, axis=-1):
    return torch.softmax(x, dim=axis)
def _gelu(x):
    return torch.nn.functional.gelu(x, approximate="tanh")
def _silu(x):
    return torch.nn.functional.silu(x)
def _sigmoid(x):
    return torch.sigmoid(x)
def _layernorm(x, axis=-1, eps=1e-5):
    m = x.mean(dim=axis, keepdim=True)
    v = x.var(dim=axis, keepdim=True, unbiased=False)
    return (x - m) / torch.sqrt(v + eps)
def _scatter_add(tgt, idx, src, axis=0):
    return tgt.clone().index_add_(axis, idx, src)
def _segment_sum(src, seg, n):
    out = torch.zeros((n,) + src.shape[1:], dtype=src.dtype)
    return out.index_add_(0, seg, src)
def _pad(x, pw):
    flat = tuple(v for pair in reversed(pw) for v in pair)
    return torch.nn.functional.pad(x, flat)

kernel_name = 'sequential_preLN__grouped_kv_mqa__moe_arch_mod__prompt'

def setup_inputs():

    _w = (lambda a: (lambda t: t.to(torch.bfloat16) if t.is_floating_point() else t)(torch.as_tensor(a)))
    def _A_setup():
        B, S, D, H = 1, 2048, 640, 32
        Dh = D // H
        return {
            "x": _w((lambda *s: torch.randn(*s, dtype=torch.bfloat16) * 0.05)(B, S, D)),
            "wq": _w((lambda *s: torch.randn(*s, dtype=torch.bfloat16) * 0.05)(D, H * Dh)),
            "wk": _w((lambda *s: torch.randn(*s, dtype=torch.bfloat16) * 0.05)(D, Dh)),
            "wv": _w((lambda *s: torch.randn(*s, dtype=torch.bfloat16) * 0.05)(D, Dh)),
            "wo": _w((lambda *s: torch.randn(*s, dtype=torch.bfloat16) * 0.05)(H * Dh, D)),
        }
    _A_in = _A_setup()

    def _B_setup():
        B, S, D, F, C = 1, 2048, 640, 1728, 1
        return {
            "x": _w((lambda *s: torch.randn(*s, dtype=torch.bfloat16) * 0.05)(B, S, D)),
            "w_r": _w((lambda *s: torch.randn(*s, dtype=torch.bfloat16) * 0.05)(D)),
            "w_gate": _w((lambda *s: torch.randn(*s, dtype=torch.bfloat16) * 0.05)(D, F)),
            "w_up": _w((lambda *s: torch.randn(*s, dtype=torch.bfloat16) * 0.05)(D, F)),
            "w_down": _w((lambda *s: torch.randn(*s, dtype=torch.bfloat16) * 0.05)(F, D)),
        }
    _B_in = _B_setup()

    return {
        "A_x": _A_in["x"],
        "A_wq": _A_in["wq"],
        "A_wk": _A_in["wk"],
        "A_wv": _A_in["wv"],
        "A_wo": _A_in["wo"],
        "B_x": _B_in["x"],
        "B_w_r": _B_in["w_r"],
        "B_w_gate": _B_in["w_gate"],
        "B_w_up": _B_in["w_up"],
        "B_w_down": _B_in["w_down"],
    }

def reference(A_x, A_wq, A_wk, A_wv, A_wo, B_x, B_w_r, B_w_gate, B_w_up, B_w_down):
    def _A_ref(x, wq, wk, wv, wo):
        B, S, D = x.shape
        H = 32
        Dh = D // H
        q = (lambda x, *d: x.permute(*d))((x @ wq).reshape(B, S, H, Dh), 0, 2, 1, 3)
        k = x @ wk
        v = x @ wv
        scores = torch.einsum("bhqd,bkd->bhqk", q, k) * (Dh ** -0.5)
        p = _softmax(scores, axis=-1)
        o = torch.einsum("bhqk,bkd->bhqd", p, v)
        return (lambda x, *d: x.permute(*d))(o, 0, 2, 1, 3).reshape(B, S, H * Dh) @ wo

    def _B_ref(x, w_r, w_gate, w_up, w_down):
        B, S, D = x.shape
        C = 1
        r = x @ w_r
        idx = torch.argsort(-r, axis=-1)[:, :C]
        idx_e = (lambda x, n, axis: torch.repeat_interleave(x, n, dim=axis))(idx.reshape(B, C, 1), D, axis=2)
        x_sel = (lambda x, i, axis: torch.take_along_dim(x, i, dim=axis))(x, idx_e, axis=1)
        g = _silu(x_sel @ w_gate)
        u = x_sel @ w_up
        y = (g * u) @ w_down
        r_sel = _sigmoid((lambda x, i, axis: torch.take_along_dim(x, i, dim=axis))(r, idx, axis=1))
        y = y * r_sel.reshape(B, C, 1)
        b_off = (torch.arange(B) * S).reshape(B, 1)
        flat_idx = (idx + b_off).reshape(B * C)
        zero = (x * 0.0).reshape(B * S, D)
        upd = _scatter_add(zero, flat_idx, y.reshape(B * C, D), axis=0)
        return x + upd.reshape(B, S, D)

    x = A_x
    h = x + _A_ref(_layernorm(x, axis=-1), A_wq, A_wk, A_wv, A_wo)
    h2 = h + _B_ref(_layernorm(h, axis=-1), B_w_r, B_w_gate, B_w_up, B_w_down)
    return h2
```

```asm
; @launch kernel=k1_kernel grid=(256,1,1) block=(256,1,1) lds=139264
; @launch kernel=k2_kernel grid=(256,1,1) block=(512,1,1) lds=163840
; @launch kernel=k3_kernel grid=(256,1,1) block=(256,1,1) lds=139264
; @launch kernel=k4_kernel grid=(182,1,1) block=(512,1,1) lds=20480
.amdgcn_target "amdgcn-amd-amdhsa--gfx950"
.text
.globl k1_kernel
.p2align 8
.type k1_kernel,@function
k1_kernel:
    s_cmp_ge_u32 s2, 256
    s_cbranch_scc1 k1_kernel_exit
    s_load_dwordx2 s[4:5], s[0:1], 0
    s_load_dwordx2 s[6:7], s[0:1], 8
    s_load_dwordx2 s[8:9], s[0:1], 16
    s_load_dwordx2 s[10:11], s[0:1], 24
    s_load_dwordx2 s[14:15], s[0:1], 48
    s_load_dwordx2 s[12:13], s[0:1], 96
    s_and_b32 s36, s2, 7
    s_lshr_b32 s37, s2, 6
    s_lshl_b32 s37, s37, 3
    s_add_u32 s36, s36, s37
    s_lshr_b32 s37, s2, 3
    s_and_b32 s37, s37, 7
    v_and_b32 v1, 63, v0
    v_and_b32 v2, 15, v0
    v_lshrrev_b32 v3, 4, v1
    v_lshrrev_b32 v5, 6, v0
    s_nop 0
    v_readfirstlane_b32 s3, v5
    s_lshl_b32 s38, s36, 6
    s_lshl_b32 s39, s3, 4
    s_add_u32 s38, s38, s39
    v_add_u32 v6, s38, v2
    v_lshrrev_b32 v7, 2, v1
    v_bfe_u32 v8, v1, 4, 2
    v_and_b32 v9, 3, v1
    v_xor_b32 v8, v8, v9
    v_add_u32 v7, s38, v7
    v_mul_u32_u24 v7, 1280, v7
    v_lshl_add_u32 v7, v8, 4, v7
    s_lshl_b32 s39, s3, 6
    v_add_u32 v8, s39, v1
    v_add_u32 v9, 256, v1
    s_mul_i32 s39, s37, 160
    v_mul_u32_u24 v10, 0x199a, v8
    v_lshrrev_b32 v10, 16, v10
    v_mul_u32_u24 v11, 10, v10
    v_sub_u32 v11, v8, v11
    v_mul_u32_u24 v10, 1280, v10
    v_lshl_add_u32 v10, v11, 4, v10
    v_add_u32 v8, s39, v10
    v_mul_u32_u24 v10, 0x199a, v9
    v_lshrrev_b32 v10, 16, v10
    v_mul_u32_u24 v11, 10, v10
    v_sub_u32 v11, v9, v11
    v_mul_u32_u24 v10, 1280, v10
    v_lshl_add_u32 v10, v11, 4, v10
    v_add_u32 v9, s39, v10
    v_lshlrev_b32 v10, 4, v1
    s_mul_i32 s39, s38, 1280
    v_lshlrev_b32 v11, 7, v1
    v_add_u32 v11, s39, v11
    s_waitcnt lgkmcnt(0)
    s_mov_b32 s28, s12
    s_and_b32 s29, s13, 0xffff
    s_mov_b32 s30, 0x1400000
    s_mov_b32 s31, 0x00020000
    s_mov_b32 s16, s4
    s_and_b32 s17, s5, 0xffff
    s_mov_b32 s18, 0x280000
    s_mov_b32 s19, 0x00020000
    s_mov_b32 s20, s6
    s_and_b32 s21, s7, 0xffff
    s_mov_b32 s22, 0xc8000
    s_mov_b32 s23, 0x00020000
    s_cmp_lt_u32 s37, 2
    s_cselect_b32 s24, s8, s10
    s_cselect_b32 s25, s9, s11
    s_and_b32 s25, s25, 0xffff
    s_mov_b32 s26, 25600
    s_mov_b32 s27, 0x00020000
    s_cmp_lt_u32 s37, 4
    s_cselect_b32 s42, 0, 0x100000
    s_mul_i32 s43, s3, 12288
    s_add_u32 s43, s43, 61440
    s_lshl_b32 s45, s3, 10
    s_mul_i32 s46, s3, 5120
    s_mul_i32 s47, s3, 40960
    s_add_u32 s40, s43, 0
    s_mov_b32 m0, s40
    s_movk_i32 s41, 0
    buffer_load_dwordx4 v7, s[16:19], s41 offen lds
    s_add_u32 s40, s43, 1024
    s_mov_b32 m0, s40
    s_movk_i32 s41, 64
    buffer_load_dwordx4 v7, s[16:19], s41 offen lds
    s_add_u32 s40, s43, 2048
    s_mov_b32 m0, s40
    s_movk_i32 s41, 128
    buffer_load_dwordx4 v7, s[16:19], s41 offen lds
    s_add_u32 s40, s43, 3072
    s_mov_b32 m0, s40
    s_movk_i32 s41, 192
    buffer_load_dwordx4 v7, s[16:19], s41 offen lds
    s_add_u32 s40, s45, 0
    s_mov_b32 m0, s40
    s_mov_b32 s41, 0
    buffer_load_dwordx4 v8, s[20:23], s41 offen lds
    s_add_u32 s40, s45, 5120
    s_mov_b32 m0, s40
    s_mov_b32 s41, 40960
    buffer_load_dwordx4 v8, s[20:23], s41 offen lds
    s_add_u32 s40, s45, 10240
    s_mov_b32 m0, s40
    s_mov_b32 s41, 81920
    buffer_load_dwordx4 v8, s[20:23], s41 offen lds
    s_add_u32 s40, s45, 15360
    s_mov_b32 m0, s40
    s_mov_b32 s41, 122880
    buffer_load_dwordx4 v8, s[20:23], s41 offen lds
    s_add_u32 s40, s46, 4096
    s_mov_b32 m0, s40
    s_add_u32 s41, s47, 0
    buffer_load_dwordx4 v9, s[20:23], s41 offen lds
    s_add_u32 s41, s45, 0
    s_add_u32 s40, s41, 110592
    s_mov_b32 m0, s40
    s_add_u32 s41, s41, s42
    buffer_load_dwordx4 v10, s[24:27], s41 offen lds
    s_add_u32 s41, s45, 4096
    s_add_u32 s40, s41, 110592
    s_mov_b32 m0, s40
    s_add_u32 s41, s41, s42
    buffer_load_dwordx4 v10, s[24:27], s41 offen lds
    s_add_u32 s41, s45, 8192
    s_add_u32 s40, s41, 110592
    s_mov_b32 m0, s40
    s_add_u32 s41, s41, s42
    buffer_load_dwordx4 v10, s[24:27], s41 offen lds
    s_add_u32 s41, s45, 12288
    s_add_u32 s40, s41, 110592
    s_mov_b32 m0, s40
    s_add_u32 s41, s41, s42
    buffer_load_dwordx4 v10, s[24:27], s41 offen lds
    s_add_u32 s41, s45, 16384
    s_add_u32 s40, s41, 110592
    s_mov_b32 m0, s40
    s_add_u32 s41, s41, s42
    buffer_load_dwordx4 v10, s[24:27], s41 offen lds
    s_add_u32 s41, s45, 20480
    s_add_u32 s40, s41, 110592
    s_mov_b32 m0, s40
    s_add_u32 s41, s41, s42
    buffer_load_dwordx4 v10, s[24:27], s41 offen lds
    s_add_u32 s41, s45, 24576
    s_add_u32 s40, s41, 110592
    s_mov_b32 m0, s40
    s_add_u32 s41, s41, s42
    buffer_load_dwordx4 v10, s[24:27], s41 offen lds
    s_add_u32 s40, s43, 4096
    s_mov_b32 m0, s40
    s_movk_i32 s41, 256
    buffer_load_dwordx4 v7, s[16:19], s41 offen lds
    s_add_u32 s40, s43, 5120
    s_mov_b32 m0, s40
    s_movk_i32 s41, 320
    buffer_load_dwordx4 v7, s[16:19], s41 offen lds
    s_add_u32 s40, s43, 6144
    s_mov_b32 m0, s40
    s_movk_i32 s41, 384
    buffer_load_dwordx4 v7, s[16:19], s41 offen lds
    s_add_u32 s40, s43, 7168
    s_mov_b32 m0, s40
    s_movk_i32 s41, 448
    buffer_load_dwordx4 v7, s[16:19], s41 offen lds
    s_add_u32 s40, s45, 20480
    s_mov_b32 m0, s40
    s_mov_b32 s41, 163840
    buffer_load_dwordx4 v8, s[20:23], s41 offen lds
    s_add_u32 s40, s45, 25600
    s_mov_b32 m0, s40
    s_mov_b32 s41, 204800
    buffer_load_dwordx4 v8, s[20:23], s41 offen lds
    s_add_u32 s40, s45, 30720
    s_mov_b32 m0, s40
    s_mov_b32 s41, 245760
    buffer_load_dwordx4 v8, s[20:23], s41 offen lds
    s_add_u32 s40, s45, 35840
    s_mov_b32 m0, s40
    s_mov_b32 s41, 286720
    buffer_load_dwordx4 v8, s[20:23], s41 offen lds
    s_add_u32 s40, s46, 24576
    s_mov_b32 m0, s40
    s_add_u32 s41, s47, 163840
    buffer_load_dwordx4 v9, s[20:23], s41 offen lds
    v_lshrrev_b32 v14, 2, v2
    v_and_b32 v15, 3, v2
    v_lshl_add_u32 v14, v3, 2, v14
    v_mul_u32_u24 v176, 40, v14
    v_lshl_add_u32 v176, v15, 3, v176
    s_and_b32 s40, s37, 1
    s_lshl_b32 s40, s40, 5
    s_add_u32 s40, s40, 110592
    v_add_u32 v176, s40, v176
    v_mul_u32_u24 v14, 160, v14
    v_lshl_add_u32 v14, v15, 3, v14
    v_add_u32 v15, 61440, v14
    v_mov_b32 v4, v176
    v_lshrrev_b32 v176, 1, v3
    v_lshrrev_b32 v177, 2, v2
    v_xor_b32 v176, v176, v177
    v_xor_b32 v177, 2, v176
    v_and_b32 v178, 1, v3
    v_lshlrev_b32 v178, 3, v178
    v_lshl_add_u32 v178, v2, 6, v178
    v_add_u32 v178, s43, v178
    v_lshl_add_u32 v10, v176, 4, v178
    v_lshl_add_u32 v11, v177, 4, v178
    v_mov_b32 v144, 0x3f803f80
    v_mov_b32 v145, 0x3f803f80
    v_mov_b32 v146, 0x3f803f80
    v_mov_b32 v147, 0x3f803f80
    s_waitcnt vmcnt(9)
    s_barrier
    s_cmp_lt_u32 s37, 4
    s_cselect_b64 vcc, -1, 0
    ds_read_b64 v[72:73], v10 offset:0
    ds_read_b64 v[74:75], v11 offset:0
    ds_read_b64_tr_b16 v[16:17], v14 offset:0
    ds_read_b64_tr_b16 v[18:19], v14 offset:2560
    ds_read_b64_tr_b16 v[20:21], v14 offset:32
    ds_read_b64_tr_b16 v[22:23], v14 offset:2592
    ds_read_b64_tr_b16 v[24:25], v14 offset:64
    ds_read_b64_tr_b16 v[26:27], v14 offset:2624
    ds_read_b64_tr_b16 v[28:29], v14 offset:96
    ds_read_b64_tr_b16 v[30:31], v14 offset:2656
    ds_read_b64_tr_b16 v[32:33], v14 offset:128
    ds_read_b64_tr_b16 v[34:35], v14 offset:2688
    s_cbranch_vccz k1_kernel_nkr_1
    ds_read_b64_tr_b16 v[56:57], v4 offset:0
    ds_read_b64_tr_b16 v[58:59], v4 offset:640
k1_kernel_nkr_1:
    s_waitcnt lgkmcnt(0)
    s_add_u32 s40, s43, 8192
    s_mov_b32 m0, s40
    s_movk_i32 s41, 512
    buffer_load_dwordx4 v7, s[16:19], s41 offen lds
    s_add_u32 s40, s43, 9216
    s_mov_b32 m0, s40
    s_movk_i32 s41, 576
    buffer_load_dwordx4 v7, s[16:19], s41 offen lds
    s_add_u32 s40, s43, 10240
    s_mov_b32 m0, s40
    s_movk_i32 s41, 640
    buffer_load_dwordx4 v7, s[16:19], s41 offen lds
    ds_read_b64 v[76:77], v10 offset:1024
    ds_read_b64 v[78:79], v11 offset:1024
    ds_read_b64_tr_b16 v[36:37], v14 offset:5120
    ds_read_b64_tr_b16 v[38:39], v14 offset:7680
    ds_read_b64_tr_b16 v[40:41], v14 offset:5152
    ds_read_b64_tr_b16 v[42:43], v14 offset:7712
    ds_read_b64_tr_b16 v[44:45], v14 offset:5184
    ds_read_b64_tr_b16 v[46:47], v14 offset:7744
    ds_read_b64_tr_b16 v[48:49], v14 offset:5216
    ds_read_b64_tr_b16 v[50:51], v14 offset:7776
    ds_read_b64_tr_b16 v[52:53], v14 offset:5248
    ds_read_b64_tr_b16 v[54:55], v14 offset:7808
    s_cbranch_vccz k1_kernel_nkr_2
    ds_read_b64_tr_b16 v[64:65], v4 offset:1280
    ds_read_b64_tr_b16 v[66:67], v4 offset:1920
k1_kernel_nkr_2:
    v_mfma_f32_16x16x32_bf16 v[80:83], v[16:19], v[72:75], 0
    v_mfma_f32_16x16x32_bf16 v[84:87], v[20:23], v[72:75], 0
    v_mfma_f32_16x16x32_bf16 v[88:91], v[24:27], v[72:75], 0
    v_mfma_f32_16x16x32_bf16 v[92:95], v[28:31], v[72:75], 0
    v_mfma_f32_16x16x32_bf16 v[96:99], v[32:35], v[72:75], 0
    v_mfma_f32_16x16x32_bf16 v[136:139], v[144:147], v[72:75], 0
    v_mfma_f32_16x16x32_bf16 v[140:143], v[72:75], v[72:75], 0
    s_cbranch_vccz k1_kernel_nk_3
    v_mfma_f32_16x16x32_bf16 v[100:103], v[56:59], v[72:75], 0
k1_kernel_nk_3:
    s_cmp_lg_u32 s3, 0
    s_cbranch_scc1 k1_kernel_nc_4
    v_mfma_f32_16x16x32_bf16 v[108:111], v[16:19], v[144:147], 0
    v_mfma_f32_16x16x32_bf16 v[112:115], v[20:23], v[144:147], 0
    v_mfma_f32_16x16x32_bf16 v[116:119], v[24:27], v[144:147], 0
    v_mfma_f32_16x16x32_bf16 v[120:123], v[28:31], v[144:147], 0
    v_mfma_f32_16x16x32_bf16 v[124:127], v[32:35], v[144:147], 0
    v_mfma_f32_16x16x32_bf16 v[128:131], v[56:59], v[144:147], 0
k1_kernel_nc_4:
    s_waitcnt lgkmcnt(0)
    s_add_u32 s40, s43, 11264
    s_mov_b32 m0, s40
    s_movk_i32 s41, 704
    buffer_load_dwordx4 v7, s[16:19], s41 offen lds
    s_add_u32 s40, s45, 40960
    s_mov_b32 m0, s40
    s_mov_b32 s41, 327680
    buffer_load_dwordx4 v8, s[20:23], s41 offen lds
    ds_read_b64 v[72:73], v10 offset:2048
    ds_read_b64 v[74:75], v11 offset:2048
    ds_read_b64_tr_b16 v[16:17], v14 offset:10240
    ds_read_b64_tr_b16 v[18:19], v14 offset:12800
    ds_read_b64_tr_b16 v[20:21], v14 offset:10272
    ds_read_b64_tr_b16 v[22:23], v14 offset:12832
    ds_read_b64_tr_b16 v[24:25], v14 offset:10304
    ds_read_b64_tr_b16 v[26:27], v14 offset:12864
    ds_read_b64_tr_b16 v[28:29], v14 offset:10336
    ds_read_b64_tr_b16 v[30:31], v14 offset:12896
    ds_read_b64_tr_b16 v[32:33], v14 offset:10368
    ds_read_b64_tr_b16 v[34:35], v14 offset:12928
    s_cbranch_vccz k1_kernel_nkr_5
    ds_read_b64_tr_b16 v[56:57], v4 offset:2560
    ds_read_b64_tr_b16 v[58:59], v4 offset:3200
k1_kernel_nkr_5:
    v_mfma_f32_16x16x32_bf16 v[80:83], v[36:39], v[76:79], v[80:83]
    v_mfma_f32_16x16x32_bf16 v[84:87], v[40:43], v[76:79], v[84:87]
    v_mfma_f32_16x16x32_bf16 v[88:91], v[44:47], v[76:79], v[88:91]
    v_mfma_f32_16x16x32_bf16 v[92:95], v[48:51], v[76:79], v[92:95]
    v_mfma_f32_16x16x32_bf16 v[96:99], v[52:55], v[76:79], v[96:99]
    v_mfma_f32_16x16x32_bf16 v[136:139], v[144:147], v[76:79], v[136:139]
    v_mfma_f32_16x16x32_bf16 v[140:143], v[76:79], v[76:79], v[140:143]
    s_cbranch_vccz k1_kernel_nk_6
    v_mfma_f32_16x16x32_bf16 v[100:103], v[64:67], v[76:79], v[100:103]
k1_kernel_nk_6:
    s_cmp_lg_u32 s3, 1
    s_cbranch_scc1 k1_kernel_nc_7
    v_mfma_f32_16x16x32_bf16 v[108:111], v[36:39], v[144:147], 0
    v_mfma_f32_16x16x32_bf16 v[112:115], v[40:43], v[144:147], 0
    v_mfma_f32_16x16x32_bf16 v[116:119], v[44:47], v[144:147], 0
    v_mfma_f32_16x16x32_bf16 v[120:123], v[48:51], v[144:147], 0
    v_mfma_f32_16x16x32_bf16 v[124:127], v[52:55], v[144:147], 0
    v_mfma_f32_16x16x32_bf16 v[128:131], v[64:67], v[144:147], 0
k1_kernel_nc_7:
    s_waitcnt lgkmcnt(0)
    s_add_u32 s40, s45, 46080
    s_mov_b32 m0, s40
    s_mov_b32 s41, 368640
    buffer_load_dwordx4 v8, s[20:23], s41 offen lds
    s_add_u32 s40, s45, 51200
    s_mov_b32 m0, s40
    s_mov_b32 s41, 409600
    buffer_load_dwordx4 v8, s[20:23], s41 offen lds
    ds_read_b64 v[76:77], v10 offset:3072
    ds_read_b64 v[78:79], v11 offset:3072
    ds_read_b64_tr_b16 v[36:37], v14 offset:15360
    ds_read_b64_tr_b16 v[38:39], v14 offset:17920
    ds_read_b64_tr_b16 v[40:41], v14 offset:15392
    ds_read_b64_tr_b16 v[42:43], v14 offset:17952
    ds_read_b64_tr_b16 v[44:45], v14 offset:15424
    ds_read_b64_tr_b16 v[46:47], v14 offset:17984
    ds_read_b64_tr_b16 v[48:49], v14 offset:15456
    ds_read_b64_tr_b16 v[50:51], v14 offset:18016
    ds_read_b64_tr_b16 v[52:53], v14 offset:15488
    ds_read_b64_tr_b16 v[54:55], v14 offset:18048
    s_cbranch_vccz k1_kernel_nkr_8
    ds_read_b64_tr_b16 v[64:65], v4 offset:3840
    ds_read_b64_tr_b16 v[66:67], v4 offset:4480
k1_kernel_nkr_8:
    v_mfma_f32_16x16x32_bf16 v[80:83], v[16:19], v[72:75], v[80:83]
    v_mfma_f32_16x16x32_bf16 v[84:87], v[20:23], v[72:75], v[84:87]
    v_mfma_f32_16x16x32_bf16 v[88:91], v[24:27], v[72:75], v[88:91]
    v_mfma_f32_16x16x32_bf16 v[92:95], v[28:31], v[72:75], v[92:95]
    v_mfma_f32_16x16x32_bf16 v[96:99], v[32:35], v[72:75], v[96:99]
    v_mfma_f32_16x16x32_bf16 v[136:139], v[144:147], v[72:75], v[136:139]
    v_mfma_f32_16x16x32_bf16 v[140:143], v[72:75], v[72:75], v[140:143]
    s_cbranch_vccz k1_kernel_nk_9
    v_mfma_f32_16x16x32_bf16 v[100:103], v[56:59], v[72:75], v[100:103]
k1_kernel_nk_9:
    s_cmp_lg_u32 s3, 2
    s_cbranch_scc1 k1_kernel_nc_10
    v_mfma_f32_16x16x32_bf16 v[108:111], v[16:19], v[144:147], 0
    v_mfma_f32_16x16x32_bf16 v[112:115], v[20:23], v[144:147], 0
    v_mfma_f32_16x16x32_bf16 v[116:119], v[24:27], v[144:147], 0
    v_mfma_f32_16x16x32_bf16 v[120:123], v[28:31], v[144:147], 0
    v_mfma_f32_16x16x32_bf16 v[124:127], v[32:35], v[144:147], 0
    v_mfma_f32_16x16x32_bf16 v[128:131], v[56:59], v[144:147], 0
k1_kernel_nc_10:
    s_waitcnt lgkmcnt(0)
    s_waitcnt vmcnt(7)
    s_barrier
    s_add_u32 s40, s45, 56320
    s_mov_b32 m0, s40
    s_mov_b32 s41, 450560
    buffer_load_dwordx4 v8, s[20:23], s41 offen lds
    s_add_u32 s40, s46, 45056
    s_mov_b32 m0, s40
    s_add_u32 s41, s47, 327680
    buffer_load_dwordx4 v9, s[20:23], s41 offen lds
    ds_read_b64 v[72:73], v10 offset:4096
    ds_read_b64 v[74:75], v11 offset:4096
    ds_read_b64_tr_b16 v[16:17], v14 offset:20480
    ds_read_b64_tr_b16 v[18:19], v14 offset:23040
    ds_read_b64_tr_b16 v[20:21], v14 offset:20512
    ds_read_b64_tr_b16 v[22:23], v14 offset:23072
    ds_read_b64_tr_b16 v[24:25], v14 offset:20544
    ds_read_b64_tr_b16 v[26:27], v14 offset:23104
    ds_read_b64_tr_b16 v[28:29], v14 offset:20576
    ds_read_b64_tr_b16 v[30:31], v14 offset:23136
    ds_read_b64_tr_b16 v[32:33], v14 offset:20608
    ds_read_b64_tr_b16 v[34:35], v14 offset:23168
    s_cbranch_vccz k1_kernel_nkr_11
    ds_read_b64_tr_b16 v[56:57], v4 offset:5120
    ds_read_b64_tr_b16 v[58:59], v4 offset:5760
k1_kernel_nkr_11:
    v_mfma_f32_16x16x32_bf16 v[80:83], v[36:39], v[76:79], v[80:83]
    v_mfma_f32_16x16x32_bf16 v[84:87], v[40:43], v[76:79], v[84:87]
    v_mfma_f32_16x16x32_bf16 v[88:91], v[44:47], v[76:79], v[88:91]
    v_mfma_f32_16x16x32_bf16 v[92:95], v[48:51], v[76:79], v[92:95]
    v_mfma_f32_16x16x32_bf16 v[96:99], v[52:55], v[76:79], v[96:99]
    v_mfma_f32_16x16x32_bf16 v[136:139], v[144:147], v[76:79], v[136:139]
    v_mfma_f32_16x16x32_bf16 v[140:143], v[76:79], v[76:79], v[140:143]
    s_cbranch_vccz k1_kernel_nk_12
    v_mfma_f32_16x16x32_bf16 v[100:103], v[64:67], v[76:79], v[100:103]
k1_kernel_nk_12:
    s_cmp_lg_u32 s3, 3
    s_cbranch_scc1 k1_kernel_nc_13
    v_mfma_f32_16x16x32_bf16 v[108:111], v[36:39], v[144:147], 0
    v_mfma_f32_16x16x32_bf16 v[112:115], v[40:43], v[144:147], 0
    v_mfma_f32_16x16x32_bf16 v[116:119], v[44:47], v[144:147], 0
    v_mfma_f32_16x16x32_bf16 v[120:123], v[48:51], v[144:147], 0
    v_mfma_f32_16x16x32_bf16 v[124:127], v[52:55], v[144:147], 0
    v_mfma_f32_16x16x32_bf16 v[128:131], v[64:67], v[144:147], 0
k1_kernel_nc_13:
    s_waitcnt lgkmcnt(0)
    s_add_u32 s40, s43, 0
    s_mov_b32 m0, s40
    s_movk_i32 s41, 768
    buffer_load_dwordx4 v7, s[16:19], s41 offen lds
    s_add_u32 s40, s43, 1024
    s_mov_b32 m0, s40
    s_movk_i32 s41, 832
    buffer_load_dwordx4 v7, s[16:19], s41 offen lds
    s_add_u32 s40, s43, 2048
    s_mov_b32 m0, s40
    s_movk_i32 s41, 896
    buffer_load_dwordx4 v7, s[16:19], s41 offen lds
    ds_read_b64 v[76:77], v10 offset:5120
    ds_read_b64 v[78:79], v11 offset:5120
    ds_read_b64_tr_b16 v[36:37], v14 offset:25600
    ds_read_b64_tr_b16 v[38:39], v14 offset:28160
    ds_read_b64_tr_b16 v[40:41], v14 offset:25632
    ds_read_b64_tr_b16 v[42:43], v14 offset:28192
    ds_read_b64_tr_b16 v[44:45], v14 offset:25664
    ds_read_b64_tr_b16 v[46:47], v14 offset:28224
    ds_read_b64_tr_b16 v[48:49], v14 offset:25696
    ds_read_b64_tr_b16 v[50:51], v14 offset:28256
    ds_read_b64_tr_b16 v[52:53], v14 offset:25728
    ds_read_b64_tr_b16 v[54:55], v14 offset:28288
    s_cbranch_vccz k1_kernel_nkr_14
    ds_read_b64_tr_b16 v[64:65], v4 offset:6400
    ds_read_b64_tr_b16 v[66:67], v4 offset:7040
k1_kernel_nkr_14:
    v_mfma_f32_16x16x32_bf16 v[80:83], v[16:19], v[72:75], v[80:83]
    v_mfma_f32_16x16x32_bf16 v[84:87], v[20:23], v[72:75], v[84:87]
    v_mfma_f32_16x16x32_bf16 v[88:91], v[24:27], v[72:75], v[88:91]
    v_mfma_f32_16x16x32_bf16 v[92:95], v[28:31], v[72:75], v[92:95]
    v_mfma_f32_16x16x32_bf16 v[96:99], v[32:35], v[72:75], v[96:99]
    v_mfma_f32_16x16x32_bf16 v[136:139], v[144:147], v[72:75], v[136:139]
    v_mfma_f32_16x16x32_bf16 v[140:143], v[72:75], v[72:75], v[140:143]
    s_cbranch_vccz k1_kernel_nk_15
    v_mfma_f32_16x16x32_bf16 v[100:103], v[56:59], v[72:75], v[100:103]
k1_kernel_nk_15:
    s_cmp_lg_u32 s3, 0
    s_cbranch_scc1 k1_kernel_nc_16
    v_mfma_f32_16x16x32_bf16 v[108:111], v[16:19], v[144:147], v[108:111]
    v_mfma_f32_16x16x32_bf16 v[112:115], v[20:23], v[144:147], v[112:115]
    v_mfma_f32_16x16x32_bf16 v[116:119], v[24:27], v[144:147], v[116:119]
    v_mfma_f32_16x16x32_bf16 v[120:123], v[28:31], v[144:147], v[120:123]
    v_mfma_f32_16x16x32_bf16 v[124:127], v[32:35], v[144:147], v[124:127]
    v_mfma_f32_16x16x32_bf16 v[128:131], v[56:59], v[144:147], v[128:131]
k1_kernel_nc_16:
    s_waitcnt lgkmcnt(0)
    s_add_u32 s40, s43, 3072
    s_mov_b32 m0, s40
    s_movk_i32 s41, 960
    buffer_load_dwordx4 v7, s[16:19], s41 offen lds
    s_add_u32 s40, s45, 0
    s_mov_b32 m0, s40
    s_mov_b32 s41, 491520
    buffer_load_dwordx4 v8, s[20:23], s41 offen lds
    ds_read_b64 v[72:73], v10 offset:6144
    ds_read_b64 v[74:75], v11 offset:6144
    ds_read_b64_tr_b16 v[16:17], v14 offset:30720
    ds_read_b64_tr_b16 v[18:19], v14 offset:33280
    ds_read_b64_tr_b16 v[20:21], v14 offset:30752
    ds_read_b64_tr_b16 v[22:23], v14 offset:33312
    ds_read_b64_tr_b16 v[24:25], v14 offset:30784
    ds_read_b64_tr_b16 v[26:27], v14 offset:33344
    ds_read_b64_tr_b16 v[28:29], v14 offset:30816
    ds_read_b64_tr_b16 v[30:31], v14 offset:33376
    ds_read_b64_tr_b16 v[32:33], v14 offset:30848
    ds_read_b64_tr_b16 v[34:35], v14 offset:33408
    s_cbranch_vccz k1_kernel_nkr_17
    ds_read_b64_tr_b16 v[56:57], v4 offset:7680
    ds_read_b64_tr_b16 v[58:59], v4 offset:8320
k1_kernel_nkr_17:
    v_mfma_f32_16x16x32_bf16 v[80:83], v[36:39], v[76:79], v[80:83]
    v_mfma_f32_16x16x32_bf16 v[84:87], v[40:43], v[76:79], v[84:87]
    v_mfma_f32_16x16x32_bf16 v[88:91], v[44:47], v[76:79], v[88:91]
    v_mfma_f32_16x16x32_bf16 v[92:95], v[48:51], v[76:79], v[92:95]
    v_mfma_f32_16x16x32_bf16 v[96:99], v[52:55], v[76:79], v[96:99]
    v_mfma_f32_16x16x32_bf16 v[136:139], v[144:147], v[76:79], v[136:139]
    v_mfma_f32_16x16x32_bf16 v[140:143], v[76:79], v[76:79], v[140:143]
    s_cbranch_vccz k1_kernel_nk_18
    v_mfma_f32_16x16x32_bf16 v[100:103], v[64:67], v[76:79], v[100:103]
k1_kernel_nk_18:
    s_cmp_lg_u32 s3, 1
    s_cbranch_scc1 k1_kernel_nc_19
    v_mfma_f32_16x16x32_bf16 v[108:111], v[36:39], v[144:147], v[108:111]
    v_mfma_f32_16x16x32_bf16 v[112:115], v[40:43], v[144:147], v[112:115]
    v_mfma_f32_16x16x32_bf16 v[116:119], v[44:47], v[144:147], v[116:119]
    v_mfma_f32_16x16x32_bf16 v[120:123], v[48:51], v[144:147], v[120:123]
    v_mfma_f32_16x16x32_bf16 v[124:127], v[52:55], v[144:147], v[124:127]
    v_mfma_f32_16x16x32_bf16 v[128:131], v[64:67], v[144:147], v[128:131]
k1_kernel_nc_19:
    s_waitcnt lgkmcnt(0)
    s_add_u32 s40, s45, 5120
    s_mov_b32 m0, s40
    s_mov_b32 s41, 532480
    buffer_load_dwordx4 v8, s[20:23], s41 offen lds
    s_add_u32 s40, s45, 10240
    s_mov_b32 m0, s40
    s_mov_b32 s41, 573440
    buffer_load_dwordx4 v8, s[20:23], s41 offen lds
    ds_read_b64 v[76:77], v10 offset:7168
    ds_read_b64 v[78:79], v11 offset:7168
    ds_read_b64_tr_b16 v[36:37], v14 offset:35840
    ds_read_b64_tr_b16 v[38:39], v14 offset:38400
    ds_read_b64_tr_b16 v[40:41], v14 offset:35872
    ds_read_b64_tr_b16 v[42:43], v14 offset:38432
    ds_read_b64_tr_b16 v[44:45], v14 offset:35904
    ds_read_b64_tr_b16 v[46:47], v14 offset:38464
    ds_read_b64_tr_b16 v[48:49], v14 offset:35936
    ds_read_b64_tr_b16 v[50:51], v14 offset:38496
    ds_read_b64_tr_b16 v[52:53], v14 offset:35968
    ds_read_b64_tr_b16 v[54:55], v14 offset:38528
    s_cbranch_vccz k1_kernel_nkr_20
    ds_read_b64_tr_b16 v[64:65], v4 offset:8960
    ds_read_b64_tr_b16 v[66:67], v4 offset:9600
k1_kernel_nkr_20:
    v_mfma_f32_16x16x32_bf16 v[80:83], v[16:19], v[72:75], v[80:83]
    v_mfma_f32_16x16x32_bf16 v[84:87], v[20:23], v[72:75], v[84:87]
    v_mfma_f32_16x16x32_bf16 v[88:91], v[24:27], v[72:75], v[88:91]
    v_mfma_f32_16x16x32_bf16 v[92:95], v[28:31], v[72:75], v[92:95]
    v_mfma_f32_16x16x32_bf16 v[96:99], v[32:35], v[72:75], v[96:99]
    v_mfma_f32_16x16x32_bf16 v[136:139], v[144:147], v[72:75], v[136:139]
    v_mfma_f32_16x16x32_bf16 v[140:143], v[72:75], v[72:75], v[140:143]
    s_cbranch_vccz k1_kernel_nk_21
    v_mfma_f32_16x16x32_bf16 v[100:103], v[56:59], v[72:75], v[100:103]
k1_kernel_nk_21:
    s_cmp_lg_u32 s3, 2
    s_cbranch_scc1 k1_kernel_nc_22
    v_mfma_f32_16x16x32_bf16 v[108:111], v[16:19], v[144:147], v[108:111]
    v_mfma_f32_16x16x32_bf16 v[112:115], v[20:23], v[144:147], v[112:115]
    v_mfma_f32_16x16x32_bf16 v[116:119], v[24:27], v[144:147], v[116:119]
    v_mfma_f32_16x16x32_bf16 v[120:123], v[28:31], v[144:147], v[120:123]
    v_mfma_f32_16x16x32_bf16 v[124:127], v[32:35], v[144:147], v[124:127]
    v_mfma_f32_16x16x32_bf16 v[128:131], v[56:59], v[144:147], v[128:131]
k1_kernel_nc_22:
    s_waitcnt lgkmcnt(0)
    s_waitcnt vmcnt(7)
    s_barrier
    s_add_u32 s40, s45, 15360
    s_mov_b32 m0, s40
    s_mov_b32 s41, 614400
    buffer_load_dwordx4 v8, s[20:23], s41 offen lds
    s_add_u32 s40, s46, 4096
    s_mov_b32 m0, s40
    s_add_u32 s41, s47, 491520
    buffer_load_dwordx4 v9, s[20:23], s41 offen lds
    ds_read_b64 v[72:73], v10 offset:8192
    ds_read_b64 v[74:75], v11 offset:8192
    ds_read_b64_tr_b16 v[16:17], v14 offset:40960
    ds_read_b64_tr_b16 v[18:19], v14 offset:43520
    ds_read_b64_tr_b16 v[20:21], v14 offset:40992
    ds_read_b64_tr_b16 v[22:23], v14 offset:43552
    ds_read_b64_tr_b16 v[24:25], v14 offset:41024
    ds_read_b64_tr_b16 v[26:27], v14 offset:43584
    ds_read_b64_tr_b16 v[28:29], v14 offset:41056
    ds_read_b64_tr_b16 v[30:31], v14 offset:43616
    ds_read_b64_tr_b16 v[32:33], v14 offset:41088
    ds_read_b64_tr_b16 v[34:35], v14 offset:43648
    s_cbranch_vccz k1_kernel_nkr_23
    ds_read_b64_tr_b16 v[56:57], v4 offset:10240
    ds_read_b64_tr_b16 v[58:59], v4 offset:10880
k1_kernel_nkr_23:
    v_mfma_f32_16x16x32_bf16 v[80:83], v[36:39], v[76:79], v[80:83]
    v_mfma_f32_16x16x32_bf16 v[84:87], v[40:43], v[76:79], v[84:87]
    v_mfma_f32_16x16x32_bf16 v[88:91], v[44:47], v[76:79], v[88:91]
    v_mfma_f32_16x16x32_bf16 v[92:95], v[48:51], v[76:79], v[92:95]
    v_mfma_f32_16x16x32_bf16 v[96:99], v[52:55], v[76:79], v[96:99]
    v_mfma_f32_16x16x32_bf16 v[136:139], v[144:147], v[76:79], v[136:139]
    v_mfma_f32_16x16x32_bf16 v[140:143], v[76:79], v[76:79], v[140:143]
    s_cbranch_vccz k1_kernel_nk_24
    v_mfma_f32_16x16x32_bf16 v[100:103], v[64:67], v[76:79], v[100:103]
k1_kernel_nk_24:
    s_cmp_lg_u32 s3, 3
    s_cbranch_scc1 k1_kernel_nc_25
    v_mfma_f32_16x16x32_bf16 v[108:111], v[36:39], v[144:147], v[108:111]
    v_mfma_f32_16x16x32_bf16 v[112:115], v[40:43], v[144:147], v[112:115]
    v_mfma_f32_16x16x32_bf16 v[116:119], v[44:47], v[144:147], v[116:119]
    v_mfma_f32_16x16x32_bf16 v[120:123], v[48:51], v[144:147], v[120:123]
    v_mfma_f32_16x16x32_bf16 v[124:127], v[52:55], v[144:147], v[124:127]
    v_mfma_f32_16x16x32_bf16 v[128:131], v[64:67], v[144:147], v[128:131]
k1_kernel_nc_25:
    s_waitcnt lgkmcnt(0)
    s_add_u32 s40, s43, 4096
    s_mov_b32 m0, s40
    s_movk_i32 s41, 1024
    buffer_load_dwordx4 v7, s[16:19], s41 offen lds
    s_add_u32 s40, s43, 5120
    s_mov_b32 m0, s40
    s_movk_i32 s41, 1088
    buffer_load_dwordx4 v7, s[16:19], s41 offen lds
    s_add_u32 s40, s43, 6144
    s_mov_b32 m0, s40
    s_movk_i32 s41, 1152
    buffer_load_dwordx4 v7, s[16:19], s41 offen lds
    ds_read_b64 v[76:77], v10 offset:9216
    ds_read_b64 v[78:79], v11 offset:9216
    ds_read_b64_tr_b16 v[36:37], v14 offset:46080
    ds_read_b64_tr_b16 v[38:39], v14 offset:48640
    ds_read_b64_tr_b16 v[40:41], v14 offset:46112
    ds_read_b64_tr_b16 v[42:43], v14 offset:48672
    ds_read_b64_tr_b16 v[44:45], v14 offset:46144
    ds_read_b64_tr_b16 v[46:47], v14 offset:48704
    ds_read_b64_tr_b16 v[48:49], v14 offset:46176
    ds_read_b64_tr_b16 v[50:51], v14 offset:48736
    ds_read_b64_tr_b16 v[52:53], v14 offset:46208
    ds_read_b64_tr_b16 v[54:55], v14 offset:48768
    s_cbranch_vccz k1_kernel_nkr_26
    ds_read_b64_tr_b16 v[64:65], v4 offset:11520
    ds_read_b64_tr_b16 v[66:67], v4 offset:12160
k1_kernel_nkr_26:
    v_mfma_f32_16x16x32_bf16 v[80:83], v[16:19], v[72:75], v[80:83]
    v_mfma_f32_16x16x32_bf16 v[84:87], v[20:23], v[72:75], v[84:87]
    v_mfma_f32_16x16x32_bf16 v[88:91], v[24:27], v[72:75], v[88:91]
    v_mfma_f32_16x16x32_bf16 v[92:95], v[28:31], v[72:75], v[92:95]
    v_mfma_f32_16x16x32_bf16 v[96:99], v[32:35], v[72:75], v[96:99]
    v_mfma_f32_16x16x32_bf16 v[136:139], v[144:147], v[72:75], v[136:139]
    v_mfma_f32_16x16x32_bf16 v[140:143], v[72:75], v[72:75], v[140:143]
    s_cbranch_vccz k1_kernel_nk_27
    v_mfma_f32_16x16x32_bf16 v[100:103], v[56:59], v[72:75], v[100:103]
k1_kernel_nk_27:
    s_cmp_lg_u32 s3, 0
    s_cbranch_scc1 k1_kernel_nc_28
    v_mfma_f32_16x16x32_bf16 v[108:111], v[16:19], v[144:147], v[108:111]
    v_mfma_f32_16x16x32_bf16 v[112:115], v[20:23], v[144:147], v[112:115]
    v_mfma_f32_16x16x32_bf16 v[116:119], v[24:27], v[144:147], v[116:119]
    v_mfma_f32_16x16x32_bf16 v[120:123], v[28:31], v[144:147], v[120:123]
    v_mfma_f32_16x16x32_bf16 v[124:127], v[32:35], v[144:147], v[124:127]
    v_mfma_f32_16x16x32_bf16 v[128:131], v[56:59], v[144:147], v[128:131]
k1_kernel_nc_28:
    s_waitcnt lgkmcnt(0)
    s_add_u32 s40, s43, 7168
    s_mov_b32 m0, s40
    s_movk_i32 s41, 1216
    buffer_load_dwordx4 v7, s[16:19], s41 offen lds
    s_add_u32 s40, s45, 20480
    s_mov_b32 m0, s40
    s_mov_b32 s41, 655360
    buffer_load_dwordx4 v8, s[20:23], s41 offen lds
    ds_read_b64 v[72:73], v10 offset:10240
    ds_read_b64 v[74:75], v11 offset:10240
    ds_read_b64_tr_b16 v[16:17], v14 offset:51200
    ds_read_b64_tr_b16 v[18:19], v14 offset:53760
    ds_read_b64_tr_b16 v[20:21], v14 offset:51232
    ds_read_b64_tr_b16 v[22:23], v14 offset:53792
    ds_read_b64_tr_b16 v[24:25], v14 offset:51264
    ds_read_b64_tr_b16 v[26:27], v14 offset:53824
    ds_read_b64_tr_b16 v[28:29], v14 offset:51296
    ds_read_b64_tr_b16 v[30:31], v14 offset:53856
    ds_read_b64_tr_b16 v[32:33], v14 offset:51328
    ds_read_b64_tr_b16 v[34:35], v14 offset:53888
    s_cbranch_vccz k1_kernel_nkr_29
    ds_read_b64_tr_b16 v[56:57], v4 offset:12800
    ds_read_b64_tr_b16 v[58:59], v4 offset:13440
k1_kernel_nkr_29:
    v_mfma_f32_16x16x32_bf16 v[80:83], v[36:39], v[76:79], v[80:83]
    v_mfma_f32_16x16x32_bf16 v[84:87], v[40:43], v[76:79], v[84:87]
    v_mfma_f32_16x16x32_bf16 v[88:91], v[44:47], v[76:79], v[88:91]
    v_mfma_f32_16x16x32_bf16 v[92:95], v[48:51], v[76:79], v[92:95]
    v_mfma_f32_16x16x32_bf16 v[96:99], v[52:55], v[76:79], v[96:99]
    v_mfma_f32_16x16x32_bf16 v[136:139], v[144:147], v[76:79], v[136:139]
    v_mfma_f32_16x16x32_bf16 v[140:143], v[76:79], v[76:79], v[140:143]
    s_cbranch_vccz k1_kernel_nk_30
    v_mfma_f32_16x16x32_bf16 v[100:103], v[64:67], v[76:79], v[100:103]
k1_kernel_nk_30:
    s_cmp_lg_u32 s3, 1
    s_cbranch_scc1 k1_kernel_nc_31
    v_mfma_f32_16x16x32_bf16 v[108:111], v[36:39], v[144:147], v[108:111]
    v_mfma_f32_16x16x32_bf16 v[112:115], v[40:43], v[144:147], v[112:115]
    v_mfma_f32_16x16x32_bf16 v[116:119], v[44:47], v[144:147], v[116:119]
    v_mfma_f32_16x16x32_bf16 v[120:123], v[48:51], v[144:147], v[120:123]
    v_mfma_f32_16x16x32_bf16 v[124:127], v[52:55], v[144:147], v[124:127]
    v_mfma_f32_16x16x32_bf16 v[128:131], v[64:67], v[144:147], v[128:131]
k1_kernel_nc_31:
    s_waitcnt lgkmcnt(0)
    s_add_u32 s40, s45, 25600
    s_mov_b32 m0, s40
    s_mov_b32 s41, 696320
    buffer_load_dwordx4 v8, s[20:23], s41 offen lds
    s_add_u32 s40, s45, 30720
    s_mov_b32 m0, s40
    s_mov_b32 s41, 737280
    buffer_load_dwordx4 v8, s[20:23], s41 offen lds
    ds_read_b64 v[76:77], v10 offset:11264
    ds_read_b64 v[78:79], v11 offset:11264
    ds_read_b64_tr_b16 v[36:37], v14 offset:56320
    ds_read_b64_tr_b16 v[38:39], v14 offset:58880
    ds_read_b64_tr_b16 v[40:41], v14 offset:56352
    ds_read_b64_tr_b16 v[42:43], v14 offset:58912
    ds_read_b64_tr_b16 v[44:45], v14 offset:56384
    ds_read_b64_tr_b16 v[46:47], v14 offset:58944
    ds_read_b64_tr_b16 v[48:49], v14 offset:56416
    ds_read_b64_tr_b16 v[50:51], v14 offset:58976
    ds_read_b64_tr_b16 v[52:53], v14 offset:56448
    ds_read_b64_tr_b16 v[54:55], v14 offset:59008
    s_cbranch_vccz k1_kernel_nkr_32
    ds_read_b64_tr_b16 v[64:65], v4 offset:14080
    ds_read_b64_tr_b16 v[66:67], v4 offset:14720
k1_kernel_nkr_32:
    v_mfma_f32_16x16x32_bf16 v[80:83], v[16:19], v[72:75], v[80:83]
    v_mfma_f32_16x16x32_bf16 v[84:87], v[20:23], v[72:75], v[84:87]
    v_mfma_f32_16x16x32_bf16 v[88:91], v[24:27], v[72:75], v[88:91]
    v_mfma_f32_16x16x32_bf16 v[92:95], v[28:31], v[72:75], v[92:95]
    v_mfma_f32_16x16x32_bf16 v[96:99], v[32:35], v[72:75], v[96:99]
    v_mfma_f32_16x16x32_bf16 v[136:139], v[144:147], v[72:75], v[136:139]
    v_mfma_f32_16x16x32_bf16 v[140:143], v[72:75], v[72:75], v[140:143]
    s_cbranch_vccz k1_kernel_nk_33
    v_mfma_f32_16x16x32_bf16 v[100:103], v[56:59], v[72:75], v[100:103]
k1_kernel_nk_33:
    s_cmp_lg_u32 s3, 2
    s_cbranch_scc1 k1_kernel_nc_34
    v_mfma_f32_16x16x32_bf16 v[108:111], v[16:19], v[144:147], v[108:111]
    v_mfma_f32_16x16x32_bf16 v[112:115], v[20:23], v[144:147], v[112:115]
    v_mfma_f32_16x16x32_bf16 v[116:119], v[24:27], v[144:147], v[116:119]
    v_mfma_f32_16x16x32_bf16 v[120:123], v[28:31], v[144:147], v[120:123]
    v_mfma_f32_16x16x32_bf16 v[124:127], v[32:35], v[144:147], v[124:127]
    v_mfma_f32_16x16x32_bf16 v[128:131], v[56:59], v[144:147], v[128:131]
k1_kernel_nc_34:
    s_waitcnt lgkmcnt(0)
    s_waitcnt vmcnt(7)
    s_barrier
    s_add_u32 s40, s45, 35840
    s_mov_b32 m0, s40
    s_mov_b32 s41, 778240
    buffer_load_dwordx4 v8, s[20:23], s41 offen lds
    s_add_u32 s40, s46, 24576
    s_mov_b32 m0, s40
    s_add_u32 s41, s47, 655360
    buffer_load_dwordx4 v9, s[20:23], s41 offen lds
    ds_read_b64 v[72:73], v10 offset:0
    ds_read_b64 v[74:75], v11 offset:0
    ds_read_b64_tr_b16 v[16:17], v14 offset:0
    ds_read_b64_tr_b16 v[18:19], v14 offset:2560
    ds_read_b64_tr_b16 v[20:21], v14 offset:32
    ds_read_b64_tr_b16 v[22:23], v14 offset:2592
    ds_read_b64_tr_b16 v[24:25], v14 offset:64
    ds_read_b64_tr_b16 v[26:27], v14 offset:2624
    ds_read_b64_tr_b16 v[28:29], v14 offset:96
    ds_read_b64_tr_b16 v[30:31], v14 offset:2656
    ds_read_b64_tr_b16 v[32:33], v14 offset:128
    ds_read_b64_tr_b16 v[34:35], v14 offset:2688
    s_cbranch_vccz k1_kernel_nkr_35
    ds_read_b64_tr_b16 v[56:57], v4 offset:15360
    ds_read_b64_tr_b16 v[58:59], v4 offset:16000
k1_kernel_nkr_35:
    v_mfma_f32_16x16x32_bf16 v[80:83], v[36:39], v[76:79], v[80:83]
    v_mfma_f32_16x16x32_bf16 v[84:87], v[40:43], v[76:79], v[84:87]
    v_mfma_f32_16x16x32_bf16 v[88:91], v[44:47], v[76:79], v[88:91]
    v_mfma_f32_16x16x32_bf16 v[92:95], v[48:51], v[76:79], v[92:95]
    v_mfma_f32_16x16x32_bf16 v[96:99], v[52:55], v[76:79], v[96:99]
    v_mfma_f32_16x16x32_bf16 v[136:139], v[144:147], v[76:79], v[136:139]
    v_mfma_f32_16x16x32_bf16 v[140:143], v[76:79], v[76:79], v[140:143]
    s_cbranch_vccz k1_kernel_nk_36
    v_mfma_f32_16x16x32_bf16 v[100:103], v[64:67], v[76:79], v[100:103]
k1_kernel_nk_36:
    s_cmp_lg_u32 s3, 3
    s_cbranch_scc1 k1_kernel_nc_37
    v_mfma_f32_16x16x32_bf16 v[108:111], v[36:39], v[144:147], v[108:111]
    v_mfma_f32_16x16x32_bf16 v[112:115], v[40:43], v[144:147], v[112:115]
    v_mfma_f32_16x16x32_bf16 v[116:119], v[44:47], v[144:147], v[116:119]
    v_mfma_f32_16x16x32_bf16 v[120:123], v[48:51], v[144:147], v[120:123]
    v_mfma_f32_16x16x32_bf16 v[124:127], v[52:55], v[144:147], v[124:127]
    v_mfma_f32_16x16x32_bf16 v[128:131], v[64:67], v[144:147], v[128:131]
k1_kernel_nc_37:
    s_waitcnt lgkmcnt(0)
    ds_read_b64 v[76:77], v10 offset:1024
    ds_read_b64 v[78:79], v11 offset:1024
    ds_read_b64_tr_b16 v[36:37], v14 offset:5120
    ds_read_b64_tr_b16 v[38:39], v14 offset:7680
    ds_read_b64_tr_b16 v[40:41], v14 offset:5152
    ds_read_b64_tr_b16 v[42:43], v14 offset:7712
    ds_read_b64_tr_b16 v[44:45], v14 offset:5184
    ds_read_b64_tr_b16 v[46:47], v14 offset:7744
    ds_read_b64_tr_b16 v[48:49], v14 offset:5216
    ds_read_b64_tr_b16 v[50:51], v14 offset:7776
    ds_read_b64_tr_b16 v[52:53], v14 offset:5248
    ds_read_b64_tr_b16 v[54:55], v14 offset:7808
    s_cbranch_vccz k1_kernel_nkr_38
    ds_read_b64_tr_b16 v[64:65], v4 offset:16640
    ds_read_b64_tr_b16 v[66:67], v4 offset:17280
k1_kernel_nkr_38:
    v_mfma_f32_16x16x32_bf16 v[80:83], v[16:19], v[72:75], v[80:83]
    v_mfma_f32_16x16x32_bf16 v[84:87], v[20:23], v[72:75], v[84:87]
    v_mfma_f32_16x16x32_bf16 v[88:91], v[24:27], v[72:75], v[88:91]
    v_mfma_f32_16x16x32_bf16 v[92:95], v[28:31], v[72:75], v[92:95]
    v_mfma_f32_16x16x32_bf16 v[96:99], v[32:35], v[72:75], v[96:99]
    v_mfma_f32_16x16x32_bf16 v[136:139], v[144:147], v[72:75], v[136:139]
    v_mfma_f32_16x16x32_bf16 v[140:143], v[72:75], v[72:75], v[140:143]
    s_cbranch_vccz k1_kernel_nk_39
    v_mfma_f32_16x16x32_bf16 v[100:103], v[56:59], v[72:75], v[100:103]
k1_kernel_nk_39:
    s_cmp_lg_u32 s3, 0
    s_cbranch_scc1 k1_kernel_nc_40
    v_mfma_f32_16x16x32_bf16 v[108:111], v[16:19], v[144:147], v[108:111]
    v_mfma_f32_16x16x32_bf16 v[112:115], v[20:23], v[144:147], v[112:115]
    v_mfma_f32_16x16x32_bf16 v[116:119], v[24:27], v[144:147], v[116:119]
    v_mfma_f32_16x16x32_bf16 v[120:123], v[28:31], v[144:147], v[120:123]
    v_mfma_f32_16x16x32_bf16 v[124:127], v[32:35], v[144:147], v[124:127]
    v_mfma_f32_16x16x32_bf16 v[128:131], v[56:59], v[144:147], v[128:131]
k1_kernel_nc_40:
    s_waitcnt lgkmcnt(0)
    ds_read_b64 v[72:73], v10 offset:2048
    ds_read_b64 v[74:75], v11 offset:2048
    ds_read_b64_tr_b16 v[16:17], v14 offset:10240
    ds_read_b64_tr_b16 v[18:19], v14 offset:12800
    ds_read_b64_tr_b16 v[20:21], v14 offset:10272
    ds_read_b64_tr_b16 v[22:23], v14 offset:12832
    ds_read_b64_tr_b16 v[24:25], v14 offset:10304
    ds_read_b64_tr_b16 v[26:27], v14 offset:12864
    ds_read_b64_tr_b16 v[28:29], v14 offset:10336
    ds_read_b64_tr_b16 v[30:31], v14 offset:12896
    ds_read_b64_tr_b16 v[32:33], v14 offset:10368
    ds_read_b64_tr_b16 v[34:35], v14 offset:12928
    s_cbranch_vccz k1_kernel_nkr_41
    ds_read_b64_tr_b16 v[56:57], v4 offset:17920
    ds_read_b64_tr_b16 v[58:59], v4 offset:18560
k1_kernel_nkr_41:
    v_mfma_f32_16x16x32_bf16 v[80:83], v[36:39], v[76:79], v[80:83]
    v_mfma_f32_16x16x32_bf16 v[84:87], v[40:43], v[76:79], v[84:87]
    v_mfma_f32_16x16x32_bf16 v[88:91], v[44:47], v[76:79], v[88:91]
    v_mfma_f32_16x16x32_bf16 v[92:95], v[48:51], v[76:79], v[92:95]
    v_mfma_f32_16x16x32_bf16 v[96:99], v[52:55], v[76:79], v[96:99]
    v_mfma_f32_16x16x32_bf16 v[136:139], v[144:147], v[76:79], v[136:139]
    v_mfma_f32_16x16x32_bf16 v[140:143], v[76:79], v[76:79], v[140:143]
    s_cbranch_vccz k1_kernel_nk_42
    v_mfma_f32_16x16x32_bf16 v[100:103], v[64:67], v[76:79], v[100:103]
k1_kernel_nk_42:
    s_cmp_lg_u32 s3, 1
    s_cbranch_scc1 k1_kernel_nc_43
    v_mfma_f32_16x16x32_bf16 v[108:111], v[36:39], v[144:147], v[108:111]
    v_mfma_f32_16x16x32_bf16 v[112:115], v[40:43], v[144:147], v[112:115]
    v_mfma_f32_16x16x32_bf16 v[116:119], v[44:47], v[144:147], v[116:119]
    v_mfma_f32_16x16x32_bf16 v[120:123], v[48:51], v[144:147], v[120:123]
    v_mfma_f32_16x16x32_bf16 v[124:127], v[52:55], v[144:147], v[124:127]
    v_mfma_f32_16x16x32_bf16 v[128:131], v[64:67], v[144:147], v[128:131]
k1_kernel_nc_43:
    s_waitcnt lgkmcnt(0)
    ds_read_b64 v[76:77], v10 offset:3072
    ds_read_b64 v[78:79], v11 offset:3072
    ds_read_b64_tr_b16 v[36:37], v14 offset:15360
    ds_read_b64_tr_b16 v[38:39], v14 offset:17920
    ds_read_b64_tr_b16 v[40:41], v14 offset:15392
    ds_read_b64_tr_b16 v[42:43], v14 offset:17952
    ds_read_b64_tr_b16 v[44:45], v14 offset:15424
    ds_read_b64_tr_b16 v[46:47], v14 offset:17984
    ds_read_b64_tr_b16 v[48:49], v14 offset:15456
    ds_read_b64_tr_b16 v[50:51], v14 offset:18016
    ds_read_b64_tr_b16 v[52:53], v14 offset:15488
    ds_read_b64_tr_b16 v[54:55], v14 offset:18048
    s_cbranch_vccz k1_kernel_nkr_44
    ds_read_b64_tr_b16 v[64:65], v4 offset:19200
    ds_read_b64_tr_b16 v[66:67], v4 offset:19840
k1_kernel_nkr_44:
    v_mfma_f32_16x16x32_bf16 v[80:83], v[16:19], v[72:75], v[80:83]
    v_mfma_f32_16x16x32_bf16 v[84:87], v[20:23], v[72:75], v[84:87]
    v_mfma_f32_16x16x32_bf16 v[88:91], v[24:27], v[72:75], v[88:91]
    v_mfma_f32_16x16x32_bf16 v[92:95], v[28:31], v[72:75], v[92:95]
    v_mfma_f32_16x16x32_bf16 v[96:99], v[32:35], v[72:75], v[96:99]
    v_mfma_f32_16x16x32_bf16 v[136:139], v[144:147], v[72:75], v[136:139]
    v_mfma_f32_16x16x32_bf16 v[140:143], v[72:75], v[72:75], v[140:143]
    s_cbranch_vccz k1_kernel_nk_45
    v_mfma_f32_16x16x32_bf16 v[100:103], v[56:59], v[72:75], v[100:103]
k1_kernel_nk_45:
    s_cmp_lg_u32 s3, 2
    s_cbranch_scc1 k1_kernel_nc_46
    v_mfma_f32_16x16x32_bf16 v[108:111], v[16:19], v[144:147], v[108:111]
    v_mfma_f32_16x16x32_bf16 v[112:115], v[20:23], v[144:147], v[112:115]
    v_mfma_f32_16x16x32_bf16 v[116:119], v[24:27], v[144:147], v[116:119]
    v_mfma_f32_16x16x32_bf16 v[120:123], v[28:31], v[144:147], v[120:123]
    v_mfma_f32_16x16x32_bf16 v[124:127], v[32:35], v[144:147], v[124:127]
    v_mfma_f32_16x16x32_bf16 v[128:131], v[56:59], v[144:147], v[128:131]
k1_kernel_nc_46:
    s_waitcnt lgkmcnt(0)
    s_waitcnt vmcnt(0)
    s_barrier
    ds_read_b64 v[72:73], v10 offset:4096
    ds_read_b64 v[74:75], v11 offset:4096
    ds_read_b64_tr_b16 v[16:17], v14 offset:20480
    ds_read_b64_tr_b16 v[18:19], v14 offset:23040
    ds_read_b64_tr_b16 v[20:21], v14 offset:20512
    ds_read_b64_tr_b16 v[22:23], v14 offset:23072
    ds_read_b64_tr_b16 v[24:25], v14 offset:20544
    ds_read_b64_tr_b16 v[26:27], v14 offset:23104
    ds_read_b64_tr_b16 v[28:29], v14 offset:20576
    ds_read_b64_tr_b16 v[30:31], v14 offset:23136
    ds_read_b64_tr_b16 v[32:33], v14 offset:20608
    ds_read_b64_tr_b16 v[34:35], v14 offset:23168
    s_cbranch_vccz k1_kernel_nkr_47
    ds_read_b64_tr_b16 v[56:57], v4 offset:20480
    ds_read_b64_tr_b16 v[58:59], v4 offset:21120
k1_kernel_nkr_47:
    v_mfma_f32_16x16x32_bf16 v[80:83], v[36:39], v[76:79], v[80:83]
    v_mfma_f32_16x16x32_bf16 v[84:87], v[40:43], v[76:79], v[84:87]
    v_mfma_f32_16x16x32_bf16 v[88:91], v[44:47], v[76:79], v[88:91]
    v_mfma_f32_16x16x32_bf16 v[92:95], v[48:51], v[76:79], v[92:95]
    v_mfma_f32_16x16x32_bf16 v[96:99], v[52:55], v[76:79], v[96:99]
    v_mfma_f32_16x16x32_bf16 v[136:139], v[144:147], v[76:79], v[136:139]
    v_mfma_f32_16x16x32_bf16 v[140:143], v[76:79], v[76:79], v[140:143]
    s_cbranch_vccz k1_kernel_nk_48
    v_mfma_f32_16x16x32_bf16 v[100:103], v[64:67], v[76:79], v[100:103]
k1_kernel_nk_48:
    s_cmp_lg_u32 s3, 3
    s_cbranch_scc1 k1_kernel_nc_49
    v_mfma_f32_16x16x32_bf16 v[108:111], v[36:39], v[144:147], v[108:111]
    v_mfma_f32_16x16x32_bf16 v[112:115], v[40:43], v[144:147], v[112:115]
    v_mfma_f32_16x16x32_bf16 v[116:119], v[44:47], v[144:147], v[116:119]
    v_mfma_f32_16x16x32_bf16 v[120:123], v[48:51], v[144:147], v[120:123]
    v_mfma_f32_16x16x32_bf16 v[124:127], v[52:55], v[144:147], v[124:127]
    v_mfma_f32_16x16x32_bf16 v[128:131], v[64:67], v[144:147], v[128:131]
k1_kernel_nc_49:
    s_waitcnt lgkmcnt(0)
    ds_read_b64 v[76:77], v10 offset:5120
    ds_read_b64 v[78:79], v11 offset:5120
    ds_read_b64_tr_b16 v[36:37], v14 offset:25600
    ds_read_b64_tr_b16 v[38:39], v14 offset:28160
    ds_read_b64_tr_b16 v[40:41], v14 offset:25632
    ds_read_b64_tr_b16 v[42:43], v14 offset:28192
    ds_read_b64_tr_b16 v[44:45], v14 offset:25664
    ds_read_b64_tr_b16 v[46:47], v14 offset:28224
    ds_read_b64_tr_b16 v[48:49], v14 offset:25696
    ds_read_b64_tr_b16 v[50:51], v14 offset:28256
    ds_read_b64_tr_b16 v[52:53], v14 offset:25728
    ds_read_b64_tr_b16 v[54:55], v14 offset:28288
    s_cbranch_vccz k1_kernel_nkr_50
    ds_read_b64_tr_b16 v[64:65], v4 offset:21760
    ds_read_b64_tr_b16 v[66:67], v4 offset:22400
k1_kernel_nkr_50:
    v_mfma_f32_16x16x32_bf16 v[80:83], v[16:19], v[72:75], v[80:83]
    v_mfma_f32_16x16x32_bf16 v[84:87], v[20:23], v[72:75], v[84:87]
    v_mfma_f32_16x16x32_bf16 v[88:91], v[24:27], v[72:75], v[88:91]
    v_mfma_f32_16x16x32_bf16 v[92:95], v[28:31], v[72:75], v[92:95]
    v_mfma_f32_16x16x32_bf16 v[96:99], v[32:35], v[72:75], v[96:99]
    v_mfma_f32_16x16x32_bf16 v[136:139], v[144:147], v[72:75], v[136:139]
    v_mfma_f32_16x16x32_bf16 v[140:143], v[72:75], v[72:75], v[140:143]
    s_cbranch_vccz k1_kernel_nk_51
    v_mfma_f32_16x16x32_bf16 v[100:103], v[56:59], v[72:75], v[100:103]
k1_kernel_nk_51:
    s_cmp_lg_u32 s3, 0
    s_cbranch_scc1 k1_kernel_nc_52
    v_mfma_f32_16x16x32_bf16 v[108:111], v[16:19], v[144:147], v[108:111]
    v_mfma_f32_16x16x32_bf16 v[112:115], v[20:23], v[144:147], v[112:115]
    v_mfma_f32_16x16x32_bf16 v[116:119], v[24:27], v[144:147], v[116:119]
    v_mfma_f32_16x16x32_bf16 v[120:123], v[28:31], v[144:147], v[120:123]
    v_mfma_f32_16x16x32_bf16 v[124:127], v[32:35], v[144:147], v[124:127]
    v_mfma_f32_16x16x32_bf16 v[128:131], v[56:59], v[144:147], v[128:131]
k1_kernel_nc_52:
    s_waitcnt lgkmcnt(0)
    ds_read_b64 v[72:73], v10 offset:6144
    ds_read_b64 v[74:75], v11 offset:6144
    ds_read_b64_tr_b16 v[16:17], v14 offset:30720
    ds_read_b64_tr_b16 v[18:19], v14 offset:33280
    ds_read_b64_tr_b16 v[20:21], v14 offset:30752
    ds_read_b64_tr_b16 v[22:23], v14 offset:33312
    ds_read_b64_tr_b16 v[24:25], v14 offset:30784
    ds_read_b64_tr_b16 v[26:27], v14 offset:33344
    ds_read_b64_tr_b16 v[28:29], v14 offset:30816
    ds_read_b64_tr_b16 v[30:31], v14 offset:33376
    ds_read_b64_tr_b16 v[32:33], v14 offset:30848
    ds_read_b64_tr_b16 v[34:35], v14 offset:33408
    s_cbranch_vccz k1_kernel_nkr_53
    ds_read_b64_tr_b16 v[56:57], v4 offset:23040
    ds_read_b64_tr_b16 v[58:59], v4 offset:23680
k1_kernel_nkr_53:
    v_mfma_f32_16x16x32_bf16 v[80:83], v[36:39], v[76:79], v[80:83]
    v_mfma_f32_16x16x32_bf16 v[84:87], v[40:43], v[76:79], v[84:87]
    v_mfma_f32_16x16x32_bf16 v[88:91], v[44:47], v[76:79], v[88:91]
    v_mfma_f32_16x16x32_bf16 v[92:95], v[48:51], v[76:79], v[92:95]
    v_mfma_f32_16x16x32_bf16 v[96:99], v[52:55], v[76:79], v[96:99]
    v_mfma_f32_16x16x32_bf16 v[136:139], v[144:147], v[76:79], v[136:139]
    v_mfma_f32_16x16x32_bf16 v[140:143], v[76:79], v[76:79], v[140:143]
    s_cbranch_vccz k1_kernel_nk_54
    v_mfma_f32_16x16x32_bf16 v[100:103], v[64:67], v[76:79], v[100:103]
k1_kernel_nk_54:
    s_cmp_lg_u32 s3, 1
    s_cbranch_scc1 k1_kernel_nc_55
    v_mfma_f32_16x16x32_bf16 v[108:111], v[36:39], v[144:147], v[108:111]
    v_mfma_f32_16x16x32_bf16 v[112:115], v[40:43], v[144:147], v[112:115]
    v_mfma_f32_16x16x32_bf16 v[116:119], v[44:47], v[144:147], v[116:119]
    v_mfma_f32_16x16x32_bf16 v[120:123], v[48:51], v[144:147], v[120:123]
    v_mfma_f32_16x16x32_bf16 v[124:127], v[52:55], v[144:147], v[124:127]
    v_mfma_f32_16x16x32_bf16 v[128:131], v[64:67], v[144:147], v[128:131]
k1_kernel_nc_55:
    s_waitcnt lgkmcnt(0)
    ds_read_b64 v[76:77], v10 offset:7168
    ds_read_b64 v[78:79], v11 offset:7168
    ds_read_b64_tr_b16 v[36:37], v14 offset:35840
    ds_read_b64_tr_b16 v[38:39], v14 offset:38400
    ds_read_b64_tr_b16 v[40:41], v14 offset:35872
    ds_read_b64_tr_b16 v[42:43], v14 offset:38432
    ds_read_b64_tr_b16 v[44:45], v14 offset:35904
    ds_read_b64_tr_b16 v[46:47], v14 offset:38464
    ds_read_b64_tr_b16 v[48:49], v14 offset:35936
    ds_read_b64_tr_b16 v[50:51], v14 offset:38496
    ds_read_b64_tr_b16 v[52:53], v14 offset:35968
    ds_read_b64_tr_b16 v[54:55], v14 offset:38528
    s_cbranch_vccz k1_kernel_nkr_56
    ds_read_b64_tr_b16 v[64:65], v4 offset:24320
    ds_read_b64_tr_b16 v[66:67], v4 offset:24960
k1_kernel_nkr_56:
    v_mfma_f32_16x16x32_bf16 v[80:83], v[16:19], v[72:75], v[80:83]
    v_mfma_f32_16x16x32_bf16 v[84:87], v[20:23], v[72:75], v[84:87]
    v_mfma_f32_16x16x32_bf16 v[88:91], v[24:27], v[72:75], v[88:91]
    v_mfma_f32_16x16x32_bf16 v[92:95], v[28:31], v[72:75], v[92:95]
    v_mfma_f32_16x16x32_bf16 v[96:99], v[32:35], v[72:75], v[96:99]
    v_mfma_f32_16x16x32_bf16 v[136:139], v[144:147], v[72:75], v[136:139]
    v_mfma_f32_16x16x32_bf16 v[140:143], v[72:75], v[72:75], v[140:143]
    s_cbranch_vccz k1_kernel_nk_57
    v_mfma_f32_16x16x32_bf16 v[100:103], v[56:59], v[72:75], v[100:103]
k1_kernel_nk_57:
    s_cmp_lg_u32 s3, 2
    s_cbranch_scc1 k1_kernel_nc_58
    v_mfma_f32_16x16x32_bf16 v[108:111], v[16:19], v[144:147], v[108:111]
    v_mfma_f32_16x16x32_bf16 v[112:115], v[20:23], v[144:147], v[112:115]
    v_mfma_f32_16x16x32_bf16 v[116:119], v[24:27], v[144:147], v[116:119]
    v_mfma_f32_16x16x32_bf16 v[120:123], v[28:31], v[144:147], v[120:123]
    v_mfma_f32_16x16x32_bf16 v[124:127], v[32:35], v[144:147], v[124:127]
    v_mfma_f32_16x16x32_bf16 v[128:131], v[56:59], v[144:147], v[128:131]
k1_kernel_nc_58:
    s_waitcnt lgkmcnt(0)
    v_mfma_f32_16x16x32_bf16 v[80:83], v[36:39], v[76:79], v[80:83]
    v_mfma_f32_16x16x32_bf16 v[84:87], v[40:43], v[76:79], v[84:87]
    v_mfma_f32_16x16x32_bf16 v[88:91], v[44:47], v[76:79], v[88:91]
    v_mfma_f32_16x16x32_bf16 v[92:95], v[48:51], v[76:79], v[92:95]
    v_mfma_f32_16x16x32_bf16 v[96:99], v[52:55], v[76:79], v[96:99]
    v_mfma_f32_16x16x32_bf16 v[136:139], v[144:147], v[76:79], v[136:139]
    v_mfma_f32_16x16x32_bf16 v[140:143], v[76:79], v[76:79], v[140:143]
    s_cbranch_vccz k1_kernel_nk_59
    v_mfma_f32_16x16x32_bf16 v[100:103], v[64:67], v[76:79], v[100:103]
k1_kernel_nk_59:
    s_cmp_lg_u32 s3, 3
    s_cbranch_scc1 k1_kernel_nc_60
    v_mfma_f32_16x16x32_bf16 v[108:111], v[36:39], v[144:147], v[108:111]
    v_mfma_f32_16x16x32_bf16 v[112:115], v[40:43], v[144:147], v[112:115]
    v_mfma_f32_16x16x32_bf16 v[116:119], v[44:47], v[144:147], v[116:119]
    v_mfma_f32_16x16x32_bf16 v[120:123], v[48:51], v[144:147], v[120:123]
    v_mfma_f32_16x16x32_bf16 v[124:127], v[52:55], v[144:147], v[124:127]
    v_mfma_f32_16x16x32_bf16 v[128:131], v[64:67], v[144:147], v[128:131]
k1_kernel_nc_60:
    s_nop 7
    s_nop 3
    s_waitcnt vmcnt(0)
    s_getpc_b64 s[50:51]
k1_kernel_ct_61:
    s_add_u32 s50, s50, k2_kernel-k1_kernel_ct_61
    s_addc_u32 s51, s51, 0
    v_lshlrev_b32 v29, 6, v1
    v_add_u32 v26, 0, v29
    v_min_u32 v26, k4_kernel_exit-k2_kernel, v26
    v_mov_b32 v27, s51
    v_add_co_u32 v26, vcc, s50, v26
    v_addc_co_u32 v27, vcc, 0, v27, vcc
    global_load_dword v28, v[26:27], off
    v_add_u32 v26, 4096, v29
    v_min_u32 v26, k4_kernel_exit-k2_kernel, v26
    v_mov_b32 v27, s51
    v_add_co_u32 v26, vcc, s50, v26
    v_addc_co_u32 v27, vcc, 0, v27, vcc
    global_load_dword v28, v[26:27], off
    v_add_u32 v26, 8192, v29
    v_min_u32 v26, k4_kernel_exit-k2_kernel, v26
    v_mov_b32 v27, s51
    v_add_co_u32 v26, vcc, s50, v26
    v_addc_co_u32 v27, vcc, 0, v27, vcc
    global_load_dword v28, v[26:27], off
    v_add_u32 v26, 12288, v29
    v_min_u32 v26, k4_kernel_exit-k2_kernel, v26
    v_mov_b32 v27, s51
    v_add_co_u32 v26, vcc, s50, v26
    v_addc_co_u32 v27, vcc, 0, v27, vcc
    global_load_dword v28, v[26:27], off
    v_add_u32 v26, 16384, v29
    v_min_u32 v26, k4_kernel_exit-k2_kernel, v26
    v_mov_b32 v27, s51
    v_add_co_u32 v26, vcc, s50, v26
    v_addc_co_u32 v27, vcc, 0, v27, vcc
    global_load_dword v28, v[26:27], off
    v_lshlrev_b32 v5, 4, v3
    v_add_u32 v5, s43, v5
    ds_write_b128 v5, v[108:111] offset:0
    ds_write_b128 v5, v[112:115] offset:64
    ds_write_b128 v5, v[116:119] offset:128
    ds_write_b128 v5, v[120:123] offset:192
    ds_write_b128 v5, v[124:127] offset:256
    ds_write_b128 v5, v[128:131] offset:320
    v_and_b32 v168, 3, v2
    v_cmp_eq_u32 vcc, 1, v168
    s_nop 1
    v_cndmask_b32 v140, v140, v141, vcc
    v_cmp_eq_u32 vcc, 2, v168
    s_nop 1
    v_cndmask_b32 v140, v140, v142, vcc
    v_cmp_eq_u32 vcc, 3, v168
    s_nop 1
    v_cndmask_b32 v140, v140, v143, vcc
    v_lshrrev_b32 v168, 2, v2
    v_cmp_eq_u32 vcc, v3, v168
    s_nop 1
    v_cndmask_b32 v140, 0, v140, vcc
    v_mov_b32 v168, v140
    v_mov_b32 v169, v140
    s_nop 1
    v_permlane32_swap_b32 v168, v169
    s_nop 1
    v_add_f32 v140, v168, v169
    v_mov_b32 v168, v140
    v_mov_b32 v169, v140
    s_nop 1
    v_permlane16_swap_b32 v168, v169
    s_nop 1
    v_add_f32 v140, v168, v169
    s_waitcnt lgkmcnt(0)
    s_barrier
    v_lshlrev_b32 v5, 4, v3
    v_add_u32 v5, 61440, v5
    ds_read_b128 v[176:179], v5 offset:0
    ds_read_b128 v[180:183], v5 offset:12288
    ds_read_b128 v[184:187], v5 offset:24576
    ds_read_b128 v[188:191], v5 offset:36864
    ds_read_b128 v[192:195], v5 offset:64
    ds_read_b128 v[196:199], v5 offset:12352
    ds_read_b128 v[200:203], v5 offset:24640
    ds_read_b128 v[204:207], v5 offset:36928
    ds_read_b128 v[208:211], v5 offset:128
    ds_read_b128 v[212:215], v5 offset:12416
    ds_read_b128 v[216:219], v5 offset:24704
    ds_read_b128 v[220:223], v5 offset:36992
    ds_read_b128 v[224:227], v5 offset:192
    ds_read_b128 v[228:231], v5 offset:12480
    ds_read_b128 v[232:235], v5 offset:24768
    ds_read_b128 v[236:239], v5 offset:37056
    ds_read_b128 v[240:243], v5 offset:256
    ds_read_b128 v[244:247], v5 offset:12544
    ds_read_b128 v[248:251], v5 offset:24832
    ds_read_b128 v[252:255], v5 offset:37120
    ds_read_b128 v[40:43], v5 offset:320
    ds_read_b128 v[44:47], v5 offset:12608
    ds_read_b128 v[48:51], v5 offset:24896
    ds_read_b128 v[52:55], v5 offset:37184
    v_mul_f32 v136, 0x3acccccd, v136
    v_mul_f32 v140, 0x3acccccd, v140
    v_fma_f32 v140, -v136, v136, v140
    v_max_f32 v140, 0, v140
    v_add_f32 v140, 0x3727c5ac, v140
    v_rsq_f32 v137, v140
    s_nop 0
    v_mul_f32 v138, 0x3ea52b5c, v137
    v_mul_u32_u24 v7, 1280, v6
    s_mul_i32 s39, s37, 160
    v_lshl_add_u32 v8, v3, 3, s39
    v_add_u32 v7, v7, v8
    s_waitcnt lgkmcnt(0)
    v_add_f32 v176, v176, v180
    v_add_f32 v184, v184, v188
    v_add_f32 v177, v177, v181
    v_add_f32 v185, v185, v189
    v_add_f32 v178, v178, v182
    v_add_f32 v186, v186, v190
    v_add_f32 v179, v179, v183
    v_add_f32 v187, v187, v191
    v_add_f32 v176, v176, v184
    v_add_f32 v177, v177, v185
    v_add_f32 v178, v178, v186
    v_add_f32 v179, v179, v187
    v_fma_f32 v80, -v136, v176, v80
    v_fma_f32 v81, -v136, v177, v81
    v_fma_f32 v82, -v136, v178, v82
    v_fma_f32 v83, -v136, v179, v83
    v_mul_f32 v80, v138, v80
    v_mul_f32 v81, v138, v81
    v_mul_f32 v82, v138, v82
    v_mul_f32 v83, v138, v83
    v_cvt_pk_bf16_f32 v16, v80, v81
    v_cvt_pk_bf16_f32 v17, v82, v83
    buffer_store_dwordx2 v[16:17], v7, s[28:31], 0 offen offset:0
    v_add_f32 v192, v192, v196
    v_add_f32 v200, v200, v204
    v_add_f32 v193, v193, v197
    v_add_f32 v201, v201, v205
    v_add_f32 v194, v194, v198
    v_add_f32 v202, v202, v206
    v_add_f32 v195, v195, v199
    v_add_f32 v203, v203, v207
    v_add_f32 v192, v192, v200
    v_add_f32 v193, v193, v201
    v_add_f32 v194, v194, v202
    v_add_f32 v195, v195, v203
    v_fma_f32 v84, -v136, v192, v84
    v_fma_f32 v85, -v136, v193, v85
    v_fma_f32 v86, -v136, v194, v86
    v_fma_f32 v87, -v136, v195, v87
    v_mul_f32 v84, v138, v84
    v_mul_f32 v85, v138, v85
    v_mul_f32 v86, v138, v86
    v_mul_f32 v87, v138, v87
    v_cvt_pk_bf16_f32 v18, v84, v85
    v_cvt_pk_bf16_f32 v19, v86, v87
    buffer_store_dwordx2 v[18:19], v7, s[28:31], 0 offen offset:32
    v_add_f32 v208, v208, v212
    v_add_f32 v216, v216, v220
    v_add_f32 v209, v209, v213
    v_add_f32 v217, v217, v221
    v_add_f32 v210, v210, v214
    v_add_f32 v218, v218, v222
    v_add_f32 v211, v211, v215
    v_add_f32 v219, v219, v223
    v_add_f32 v208, v208, v216
    v_add_f32 v209, v209, v217
    v_add_f32 v210, v210, v218
    v_add_f32 v211, v211, v219
    v_fma_f32 v88, -v136, v208, v88
    v_fma_f32 v89, -v136, v209, v89
    v_fma_f32 v90, -v136, v210, v90
    v_fma_f32 v91, -v136, v211, v91
    v_mul_f32 v88, v138, v88
    v_mul_f32 v89, v138, v89
    v_mul_f32 v90, v138, v90
    v_mul_f32 v91, v138, v91
    v_cvt_pk_bf16_f32 v20, v88, v89
    v_cvt_pk_bf16_f32 v21, v90, v91
    buffer_store_dwordx2 v[20:21], v7, s[28:31], 0 offen offset:64
    v_add_f32 v224, v224, v228
    v_add_f32 v232, v232, v236
    v_add_f32 v225, v225, v229
    v_add_f32 v233, v233, v237
    v_add_f32 v226, v226, v230
    v_add_f32 v234, v234, v238
    v_add_f32 v227, v227, v231
    v_add_f32 v235, v235, v239
    v_add_f32 v224, v224, v232
    v_add_f32 v225, v225, v233
    v_add_f32 v226, v226, v234
    v_add_f32 v227, v227, v235
    v_fma_f32 v92, -v136, v224, v92
    v_fma_f32 v93, -v136, v225, v93
    v_fma_f32 v94, -v136, v226, v94
    v_fma_f32 v95, -v136, v227, v95
    v_mul_f32 v92, v138, v92
    v_mul_f32 v93, v138, v93
    v_mul_f32 v94, v138, v94
    v_mul_f32 v95, v138, v95
    v_cvt_pk_bf16_f32 v22, v92, v93
    v_cvt_pk_bf16_f32 v23, v94, v95
    buffer_store_dwordx2 v[22:23], v7, s[28:31], 0 offen offset:96
    v_add_f32 v240, v240, v244
    v_add_f32 v248, v248, v252
    v_add_f32 v241, v241, v245
    v_add_f32 v249, v249, v253
    v_add_f32 v242, v242, v246
    v_add_f32 v250, v250, v254
    v_add_f32 v243, v243, v247
    v_add_f32 v251, v251, v255
    v_add_f32 v240, v240, v248
    v_add_f32 v241, v241, v249
    v_add_f32 v242, v242, v250
    v_add_f32 v243, v243, v251
    v_fma_f32 v96, -v136, v240, v96
    v_fma_f32 v97, -v136, v241, v97
    v_fma_f32 v98, -v136, v242, v98
    v_fma_f32 v99, -v136, v243, v99
    v_mul_f32 v96, v138, v96
    v_mul_f32 v97, v138, v97
    v_mul_f32 v98, v138, v98
    v_mul_f32 v99, v138, v99
    v_cvt_pk_bf16_f32 v24, v96, v97
    v_cvt_pk_bf16_f32 v25, v98, v99
    buffer_store_dwordx2 v[24:25], v7, s[28:31], 0 offen offset:128
    s_cmp_ge_u32 s37, 4
    s_cbranch_scc1 k1_kernel_z_63
    v_add_f32 v40, v40, v44
    v_add_f32 v48, v48, v52
    v_add_f32 v41, v41, v45
    v_add_f32 v49, v49, v53
    v_add_f32 v42, v42, v46
    v_add_f32 v50, v50, v54
    v_add_f32 v43, v43, v47
    v_add_f32 v51, v51, v55
    v_add_f32 v40, v40, v48
    v_add_f32 v41, v41, v49
    v_add_f32 v42, v42, v50
    v_add_f32 v43, v43, v51
    v_fma_f32 v100, -v136, v40, v100
    v_fma_f32 v101, -v136, v41, v101
    v_fma_f32 v102, -v136, v42, v102
    v_fma_f32 v103, -v136, v43, v103
    v_mul_f32 v100, v137, v100
    v_mul_f32 v101, v137, v101
    v_mul_f32 v102, v137, v102
    v_mul_f32 v103, v137, v103
    v_cvt_pk_bf16_f32 v36, v100, v101
    v_cvt_pk_bf16_f32 v37, v102, v103
    v_lshrrev_b32 v8, 5, v6
    v_mul_u32_u24 v8, 2560, v8
    v_add_u32 v8, 0x280000, v8
    v_and_b32 v9, 31, v6
    v_cmp_eq_u32 vcc, 0, v3
    v_mov_b32 v168, 0
    v_dot2c_f32_bf16 v168, v36, v36
    v_dot2c_f32_bf16 v168, v37, v37
    s_cmp_ge_u32 s37, 2
    s_cbranch_scc1 k1_kernel_v_62
    s_cmp_eq_u32 s37, 1
    s_cbranch_scc1 k1_kernel_k1_64
    v_lshrrev_b32 v10, 1, v3
    v_lshl_add_u32 v10, v10, 5, v9
    v_lshlrev_b32 v10, 4, v10
    v_and_b32 v11, 1, v3
    v_lshl_add_u32 v10, v11, 3, v10
    v_add_u32 v10, v10, v8
    buffer_store_dwordx2 v[36:37], v10, s[28:31], 0 offen
    s_branch k1_kernel_kn_65
k1_kernel_k1_64:
    v_lshl_add_u32 v10, v9, 3, v8
    v_cndmask_b32 v168, 0, v168, vcc
    s_and_saveexec_b64 s[40:41], vcc
    buffer_store_dwordx2 v[36:37], v10, s[28:31], 0 offen offset:1024
    s_mov_b64 exec, s[40:41]
k1_kernel_kn_65:
    s_nop 3
    v_mov_b32 v170, v168
    v_mov_b32 v171, v168
    s_nop 1
    v_permlane32_swap_b32 v170, v171
    s_nop 1
    v_add_f32 v168, v170, v171
    v_mov_b32 v170, v168
    v_mov_b32 v171, v168
    s_nop 1
    v_permlane16_swap_b32 v170, v171
    s_nop 1
    v_add_f32 v168, v170, v171
    s_nop 1
    v_max_f32_dpp v168, v168, v168 row_ror:8 row_mask:0xf bank_mask:0xf
    s_nop 1
    v_max_f32_dpp v168, v168, v168 row_ror:4 row_mask:0xf bank_mask:0xf
    s_nop 1
    v_max_f32_dpp v168, v168, v168 row_ror:2 row_mask:0xf bank_mask:0xf
    s_nop 1
    v_max_f32_dpp v168, v168, v168 row_ror:1 row_mask:0xf bank_mask:0xf
    s_lshl_b32 s39, s36, 2
    s_add_u32 s39, s39, s3
    s_lshl_b32 s39, s39, 2
    s_lshl_b32 s40, s37, 9
    s_add_u32 s39, s39, s40
    s_add_u32 s39, s39, 0x2a8000
    v_mov_b32 v10, s39
    buffer_store_dword v168, v10, s[28:31], 0 offen
    s_branch k1_kernel_end
k1_kernel_v_62:
    v_lshrrev_b32 v10, 4, v9
    v_mul_u32_u24 v10, 640, v10
    v_bfe_u32 v11, v9, 2, 1
    v_mul_u32_u24 v11, 320, v11
    v_add3_u32 v10, v10, v11, v8
    v_and_b32 v11, 3, v9
    v_lshl_add_u32 v10, v11, 1, v10
    v_bfe_u32 v11, v9, 3, 1
    v_lshl_add_u32 v10, v11, 3, v10
    v_lshl_add_u32 v10, v3, 6, v10
    s_cmp_eq_u32 s37, 3
    s_cbranch_scc1 k1_kernel_v1_66
    buffer_store_short v36, v10, s[28:31], 0 offen offset:1280
    buffer_store_short_d16_hi v36, v10, s[28:31], 0 offen offset:1296
    buffer_store_short v37, v10, s[28:31], 0 offen offset:1312
    buffer_store_short_d16_hi v37, v10, s[28:31], 0 offen offset:1328
    s_branch k1_kernel_end
k1_kernel_v1_66:
    s_and_saveexec_b64 s[40:41], vcc
    buffer_store_short v36, v10, s[28:31], 0 offen offset:1536
    buffer_store_short_d16_hi v36, v10, s[28:31], 0 offen offset:1552
    buffer_store_short v37, v10, s[28:31], 0 offen offset:1568
    buffer_store_short_d16_hi v37, v10, s[28:31], 0 offen offset:1584
    s_mov_b64 exec, s[40:41]
    s_branch k1_kernel_end
k1_kernel_z_63:
    s_cmp_lg_u32 s2, 40
    s_cbranch_scc1 k1_kernel_z2_67
    v_lshlrev_b32 v10, 4, v0
    v_add_u32 v10, 0x811000, v10
    v_mov_b32 v168, 0
    v_mov_b32 v169, 0
    v_mov_b32 v170, 0
    v_mov_b32 v171, 0
    buffer_store_dwordx4 v[168:171], v10, s[28:31], 0 offen
    s_mov_b32 s32, s14
    s_and_b32 s33, s15, 0xffff
    s_mov_b32 s34, 0x500
    s_mov_b32 s35, 0x00020000
    v_mul_u32_u24 v10, 20, v1
    buffer_load_dwordx4 v[172:175], v10, s[32:35], 0 offen
    buffer_load_dword v176, v10, s[32:35], 0 offen offset:16
    v_mov_b32 v177, 0
    s_waitcnt vmcnt(0)
    v_dot2c_f32_bf16 v177, v172, v144
    v_dot2c_f32_bf16 v177, v173, v144
    v_dot2c_f32_bf16 v177, v174, v144
    v_dot2c_f32_bf16 v177, v175, v144
    v_dot2c_f32_bf16 v177, v176, v144
    s_nop 3
    s_nop 1
    v_add_f32_dpp v178, v177, v177 row_ror:8 row_mask:0xf bank_mask:0xf
    v_mov_b32 v177, v178
    s_nop 1
    v_add_f32_dpp v178, v177, v177 row_ror:4 row_mask:0xf bank_mask:0xf
    v_mov_b32 v177, v178
    s_nop 1
    v_add_f32_dpp v178, v177, v177 row_ror:2 row_mask:0xf bank_mask:0xf
    v_mov_b32 v177, v178
    s_nop 1
    v_add_f32_dpp v178, v177, v177 row_ror:1 row_mask:0xf bank_mask:0xf
    v_mov_b32 v177, v178
    v_mov_b32 v178, v177
    v_mov_b32 v179, v177
    s_nop 1
    v_permlane16_swap_b32 v178, v179
    s_nop 1
    v_add_f32 v177, v178, v179
    v_mov_b32 v178, v177
    v_mov_b32 v179, v177
    s_nop 1
    v_permlane32_swap_b32 v178, v179
    s_nop 1
    v_add_f32 v177, v178, v179
    v_mov_b32 v10, 0x810000
    buffer_store_dword v177, v10, s[28:31], 0 offen
    s_branch k1_kernel_end
k1_kernel_z2_67:
    s_cmp_lg_u32 s37, 4
    s_cbranch_scc1 k1_kernel_end
    s_lshl_b32 s39, s36, 10
    s_add_u32 s39, s39, 0x2a9000
    v_lshlrev_b32 v10, 4, v1
    v_add_u32 v10, s39, v10
    v_mov_b32 v168, 0
    v_mov_b32 v169, 0
    v_mov_b32 v170, 0
    v_mov_b32 v171, 0
    buffer_store_dwordx4 v[168:171], v10, s[28:31], 0 offen
    s_lshl_b32 s39, s36, 8
    s_add_u32 s39, s39, 0x814000
    v_mov_b32 v10, s39
    buffer_store_dword v168, v10, s[28:31], 0 offen
k1_kernel_end:
k1_kernel_exit:
    s_endpgm
.section .rodata,"a"
.p2align 6
.amdhsa_kernel k1_kernel
  .amdhsa_next_free_vgpr 256
  .amdhsa_next_free_sgpr 56
  .amdhsa_accum_offset 256
  .amdhsa_group_segment_fixed_size 0
  .amdhsa_kernarg_size 104
  .amdhsa_user_sgpr_count 2
  .amdhsa_user_sgpr_kernarg_segment_ptr 1
  .amdhsa_system_sgpr_workgroup_id_x 1
.end_amdhsa_kernel

.text
.globl k2_kernel
.p2align 8
.type k2_kernel,@function
k2_kernel:
    s_cmp_ge_u32 s2, 256
    s_cbranch_scc1 k2_kernel_exit
    s_load_dwordx2 s[4:5], s[0:1], 96
    s_load_dwordx2 s[24:25], s[0:1], 32
    s_load_dwordx4 s[28:31], s[0:1], 56
    s_load_dwordx2 s[26:27], s[0:1], 72
    v_and_b32 v1, 63, v0
    v_and_b32 v2, 31, v0
    v_lshrrev_b32 v3, 5, v1
    v_lshrrev_b32 v7, 6, v0
    s_nop 0
    v_readfirstlane_b32 s3, v7
    s_mov_b32 s14, 0x000fffff
    s_mov_b32 s15, 0x000fffff
    s_mov_b32 s18, 0x07060302
    s_waitcnt lgkmcnt(0)
    s_mov_b32 s8, s4
    s_and_b32 s9, s5, 0xffff
    s_mov_b32 s10, 0x1400000
    s_mov_b32 s11, 0x00020000
    s_and_b32 s12, s3, 3
    s_lshr_b32 s13, s3, 2
    s_lshl_b32 s19, s2, 3
    s_lshl_b32 s17, s12, 1
    s_add_u32 s19, s19, s17
    s_mul_i32 s19, s19, 1280
    v_mul_u32_u24 v8, 40, v2
    v_lshl_add_u32 v8, v3, 4, v8
    v_add_u32 v8, s19, v8
    v_mov_b32 v20, 0
    v_mov_b32 v21, 0
    v_mov_b32 v22, 0
    v_mov_b32 v23, 0
    v_mov_b32 v28, 0
    v_mov_b32 v29, 0
    v_mov_b32 v30, 0
    v_mov_b32 v31, 0
    buffer_load_dwordx4 v[16:19], v8, s[8:11], 0 offen offset:0
    buffer_load_dwordx4 v[24:27], v8, s[8:11], 0 offen offset:1280
    s_mov_b32 s20, -1
    s_mov_b32 s21, 0
    s_mov_b64 exec, s[20:21]
    buffer_load_dwordx2 v[20:21], v8, s[8:11], 0 offen offset:32
    buffer_load_dwordx2 v[28:29], v8, s[8:11], 0 offen offset:1312
    s_mov_b64 exec, -1
    v_lshlrev_b32 v9, 3, v1
    v_add_u32 v9, 0x2a8000, v9
    buffer_load_dwordx2 v[10:11], v9, s[8:11], 0 offen
    buffer_load_dwordx2 v[14:15], v9, s[8:11], 0 offen offset:512
    v_lshlrev_b32 v7, 4, v1
    v_add_u32 v7, 0x280000, v7
    s_lshl_b32 s22, s3, 10
    s_mov_b32 m0, s22
    s_add_u32 s23, s22, 81920
    buffer_load_dwordx4 v7, s[8:11], s22 offen lds
    s_mov_b32 m0, s23
    s_add_u32 s22, s22, 8192
    buffer_load_dwordx4 v7, s[8:11], s23 offen lds
    s_mov_b32 m0, s22
    s_add_u32 s23, s22, 81920
    buffer_load_dwordx4 v7, s[8:11], s22 offen lds
    s_mov_b32 m0, s23
    s_add_u32 s22, s22, 8192
    buffer_load_dwordx4 v7, s[8:11], s23 offen lds
    s_mov_b32 m0, s22
    s_add_u32 s23, s22, 81920
    buffer_load_dwordx4 v7, s[8:11], s22 offen lds
    s_mov_b32 m0, s23
    s_add_u32 s22, s22, 8192
    buffer_load_dwordx4 v7, s[8:11], s23 offen lds
    s_mov_b32 m0, s22
    s_add_u32 s23, s22, 81920
    buffer_load_dwordx4 v7, s[8:11], s22 offen lds
    s_mov_b32 m0, s23
    s_add_u32 s22, s22, 8192
    buffer_load_dwordx4 v7, s[8:11], s23 offen lds
    s_mov_b32 s32, s24
    s_and_b32 s33, s25, 0xffff
    s_mov_b32 s34, 0xc8000
    s_mov_b32 s35, 0x00020000
    s_mov_b32 s36, s28
    s_and_b32 s37, s29, 0xffff
    s_mov_b32 s38, 0x21c000
    s_mov_b32 s39, 0x00020000
    s_mov_b32 s40, s30
    s_and_b32 s41, s31, 0xffff
    s_mov_b32 s42, 0x21c000
    s_mov_b32 s43, 0x00020000
    s_mov_b32 s44, s26
    s_and_b32 s45, s27, 0xffff
    s_mov_b32 s46, 0x21c000
    s_mov_b32 s47, 0x00020000
    v_mov_b32 v144, 0
    v_mov_b32 v145, 0
    v_mov_b32 v146, 0
    v_mov_b32 v147, 0
    v_mov_b32 v148, 0
    v_mov_b32 v149, 0
    v_mov_b32 v150, 0
    v_mov_b32 v151, 0
    v_mov_b32 v152, 0
    v_mov_b32 v153, 0
    v_mov_b32 v154, 0
    v_mov_b32 v155, 0
    v_mov_b32 v156, 0
    v_mov_b32 v157, 0
    v_mov_b32 v158, 0
    v_mov_b32 v159, 0
    v_mov_b32 v176, 0
    v_mov_b32 v160, 0
    v_mov_b32 v161, 0
    v_mov_b32 v162, 0
    v_mov_b32 v163, 0
    v_mov_b32 v164, 0
    v_mov_b32 v165, 0
    v_mov_b32 v166, 0
    v_mov_b32 v167, 0
    v_mov_b32 v168, 0
    v_mov_b32 v169, 0
    v_mov_b32 v170, 0
    v_mov_b32 v171, 0
    v_mov_b32 v172, 0
    v_mov_b32 v173, 0
    v_mov_b32 v174, 0
    v_mov_b32 v175, 0
    v_mov_b32 v177, 0
    v_mov_b32 v38, 0
    v_mov_b32 v39, 0
    v_mov_b32 v46, 0
    v_mov_b32 v47, 0
    v_cmp_eq_u32 vcc, 20, v2
    v_mov_b32 v12, 0x3f803f80
    s_nop 1
    v_cndmask_b32 v12, 0, v12, vcc
    v_mov_b32 v48, v12
    v_mov_b32 v49, v12
    v_mov_b32 v50, v12
    v_mov_b32 v51, v12
    v_mov_b32 v52, v12
    v_mov_b32 v53, v12
    v_mov_b32 v54, v12
    v_mov_b32 v55, v12
    v_mov_b32 v56, v12
    v_mov_b32 v57, v12
    v_mov_b32 v58, v12
    v_mov_b32 v59, v12
    v_mov_b32 v60, v12
    v_mov_b32 v61, v12
    v_mov_b32 v62, v12
    v_mov_b32 v63, v12
    s_mul_i32 s17, s13, 81920
    v_lshlrev_b32 v4, 4, v1
    v_add_u32 v4, s17, v4
    v_lshlrev_b32 v5, 3, v2
    v_add_u32 v5, s17, v5
    v_min_u32 v6, 19, v2
    v_mul_u32_u24 v12, 20, v3
    v_add_u32 v6, v6, v12
    v_lshlrev_b32 v6, 4, v6
    v_add_u32 v6, s17, v6
    s_waitcnt vmcnt(8)
    v_max_f32 v10, v10, v11
    v_max_f32 v14, v14, v15
    s_nop 1
    v_max_f32_dpp v10, v10, v10 row_ror:8 row_mask:0xf bank_mask:0xf
    s_nop 1
    v_max_f32_dpp v10, v10, v10 row_ror:4 row_mask:0xf bank_mask:0xf
    s_nop 1
    v_max_f32_dpp v10, v10, v10 row_ror:2 row_mask:0xf bank_mask:0xf
    s_nop 1
    v_max_f32_dpp v10, v10, v10 row_ror:1 row_mask:0xf bank_mask:0xf
    v_mov_b32 v12, v10
    v_mov_b32 v13, v10
    s_nop 1
    v_permlane16_swap_b32 v12, v13
    s_nop 1
    v_max_f32 v10, v12, v13
    v_mov_b32 v12, v10
    v_mov_b32 v13, v10
    s_nop 1
    v_permlane32_swap_b32 v12, v13
    s_nop 1
    v_max_f32 v10, v12, v13
    s_nop 1
    v_max_f32_dpp v14, v14, v14 row_ror:8 row_mask:0xf bank_mask:0xf
    s_nop 1
    v_max_f32_dpp v14, v14, v14 row_ror:4 row_mask:0xf bank_mask:0xf
    s_nop 1
    v_max_f32_dpp v14, v14, v14 row_ror:2 row_mask:0xf bank_mask:0xf
    s_nop 1
    v_max_f32_dpp v14, v14, v14 row_ror:1 row_mask:0xf bank_mask:0xf
    v_mov_b32 v12, v14
    v_mov_b32 v13, v14
    s_nop 1
    v_permlane16_swap_b32 v12, v13
    s_nop 1
    v_max_f32 v14, v12, v13
    v_mov_b32 v12, v14
    v_mov_b32 v13, v14
    s_nop 1
    v_permlane32_swap_b32 v12, v13
    s_nop 1
    v_max_f32 v14, v12, v13
    v_add_f32 v10, v10, v14
    v_mov_b32 v12, 0
    v_mov_b32 v13, 0
    v_dot2c_f32_bf16 v12, v16, v16
    v_dot2c_f32_bf16 v12, v17, v17
    v_dot2c_f32_bf16 v12, v18, v18
    v_dot2c_f32_bf16 v12, v19, v19
    v_dot2c_f32_bf16 v12, v20, v20
    v_dot2c_f32_bf16 v12, v21, v21
    v_dot2c_f32_bf16 v13, v24, v24
    v_dot2c_f32_bf16 v13, v25, v25
    v_dot2c_f32_bf16 v13, v26, v26
    v_dot2c_f32_bf16 v13, v27, v27
    v_dot2c_f32_bf16 v13, v28, v28
    v_dot2c_f32_bf16 v13, v29, v29
    s_nop 3
    v_max_f32 v12, v12, v13
    v_mov_b32 v13, v12
    v_mov_b32 v14, v12
    s_nop 1
    v_permlane32_swap_b32 v13, v14
    s_nop 1
    v_add_f32 v12, v13, v14
    v_mul_f32 v12, v12, v10
    v_mov_b32 v13, 0x45098000
    v_cmp_nle_f32 vcc, v12, v13
    s_waitcnt vmcnt(0)
    s_barrier
    s_cmp_lg_u64 vcc, 0
    s_cbranch_scc1 k2_kernel_slow
    ds_read_b128 v[32:35], v4 offset:0
    ds_read_b64 v[36:37], v5 offset:1024
    s_waitcnt lgkmcnt(0)
    v_mfma_f32_32x32x16_bf16 v[64:79], v[32:35], v[16:19], 0
    v_mfma_f32_32x32x16_bf16 v[64:79], v[36:39], v[20:23], v[64:79]
    v_mfma_f32_32x32x16_bf16 v[80:95], v[32:35], v[24:27], 0
    v_mfma_f32_32x32x16_bf16 v[80:95], v[36:39], v[28:31], v[80:95]
    ds_read_b128 v[40:43], v4 offset:2560
    ds_read_b64 v[44:45], v5 offset:3584
    s_mov_b64 exec, s[14:15]
    ds_read_b128 v[48:51], v6 offset:1280
    ds_read_b128 v[52:55], v6 offset:1920
    s_mov_b64 exec, -1
    s_mov_b32 s16, 0
k2_kernel_loop:
    s_cmp_lg_u32 s16, 2
    s_cbranch_scc1 k2_kernel_now
    s_waitcnt vmcnt(0)
    s_barrier
    s_lshr_b32 s17, s2, 3
    s_lshl_b32 s17, s17, 3
    s_add_u32 s17, s17, s3
    s_lshl_b32 s17, s17, 6
    v_add_u32 v178, s17, v1
    s_and_b32 s17, s2, 7
    v_lshlrev_b32 v179, 7, v178
    buffer_load_dword v183, v179, s[32:35], 0 offen
    s_mov_b32 s23, 104858
    v_mul_lo_u32 v179, v178, s23
    v_lshrrev_b32 v179, 26, v179
    v_mul_u32_u24 v180, 640, v179
    v_sub_u32 v180, v178, v180
    v_lshl_add_u32 v179, v179, 3, s17
    v_mul_u32_u24 v180, 3456, v180
    v_lshl_add_u32 v180, v179, 6, v180
    v_cmp_gt_u32 vcc, 54, v179
    v_mov_b32 v181, 0x7ffffff0
    s_nop 0
    v_cndmask_b32 v180, v181, v180, vcc
    buffer_load_dword v183, v180, s[36:39], 0 offen
    buffer_load_dword v183, v180, s[40:43], 0 offen
    v_mul_lo_u32 v179, v178, s23
    v_lshrrev_b32 v179, 25, v179
    v_mul_u32_u24 v180, 320, v179
    v_sub_u32 v180, v178, v180
    v_lshl_add_u32 v179, v179, 3, s17
    v_mul_u32_u24 v179, 320, v179
    v_add_u32 v180, v180, v179
    v_lshlrev_b32 v180, 7, v180
    buffer_load_dword v183, v180, s[44:47], 0 offen
k2_kernel_now:
    s_waitcnt lgkmcnt(0)
    s_cmp_ge_u32 s16, 2
    s_cbranch_scc1 k2_kernel_nd_1
    s_mov_b32 m0, s22
    s_add_u32 s23, s22, 81920
    buffer_load_dwordx4 v7, s[8:11], s22 offen lds
    s_mov_b32 m0, s23
    s_add_u32 s22, s22, 8192
    buffer_load_dwordx4 v7, s[8:11], s23 offen lds
k2_kernel_nd_1:
    ds_read_b128 v[32:35], v4 offset:5120
    ds_read_b64 v[36:37], v5 offset:6144
    s_mov_b64 exec, s[14:15]
    ds_read_b128 v[56:59], v6 offset:3840
    ds_read_b128 v[60:63], v6 offset:4480
    s_mov_b64 exec, -1
    v_mfma_f32_32x32x16_bf16 v[96:111], v[40:43], v[16:19], 0
    v_exp_f32 v64, v64
    v_exp_f32 v65, v65
    v_exp_f32 v66, v66
    v_exp_f32 v67, v67
    v_mfma_f32_32x32x16_bf16 v[96:111], v[44:47], v[20:23], v[96:111]
    v_exp_f32 v68, v68
    v_exp_f32 v69, v69
    v_exp_f32 v70, v70
    v_exp_f32 v71, v71
    v_perm_b32 v128, v65, v64, s18
    v_perm_b32 v129, v67, v66, s18
    v_mfma_f32_32x32x16_bf16 v[112:127], v[40:43], v[24:27], 0
    v_exp_f32 v72, v72
    v_exp_f32 v73, v73
    v_exp_f32 v74, v74
    v_exp_f32 v75, v75
    v_perm_b32 v130, v69, v68, s18
    v_perm_b32 v131, v71, v70, s18
    v_mfma_f32_32x32x16_bf16 v[112:127], v[44:47], v[28:31], v[112:127]
    v_exp_f32 v76, v76
    v_exp_f32 v77, v77
    v_exp_f32 v78, v78
    v_exp_f32 v79, v79
    v_perm_b32 v132, v73, v72, s18
    v_perm_b32 v133, v75, v74, s18
    v_exp_f32 v80, v80
    v_exp_f32 v81, v81
    v_perm_b32 v134, v77, v76, s18
    v_perm_b32 v135, v79, v78, s18
    v_mfma_f32_32x32x16_bf16 v[144:159], v[48:51], v[128:131], v[144:159]
    v_exp_f32 v82, v82
    v_exp_f32 v83, v83
    v_exp_f32 v84, v84
    v_exp_f32 v85, v85
    v_mfma_f32_32x32x16_bf16 v[144:159], v[52:55], v[132:135], v[144:159]
    v_exp_f32 v86, v86
    v_exp_f32 v87, v87
    v_exp_f32 v88, v88
    v_exp_f32 v89, v89
    v_perm_b32 v136, v81, v80, s18
    v_perm_b32 v137, v83, v82, s18
    v_perm_b32 v138, v85, v84, s18
    v_perm_b32 v139, v87, v86, s18
    v_exp_f32 v90, v90
    v_exp_f32 v91, v91
    v_exp_f32 v92, v92
    v_mfma_f32_32x32x16_bf16 v[160:175], v[48:51], v[136:139], v[160:175]
    v_exp_f32 v93, v93
    v_exp_f32 v94, v94
    v_exp_f32 v95, v95
    v_perm_b32 v140, v89, v88, s18
    v_perm_b32 v141, v91, v90, s18
    v_perm_b32 v142, v93, v92, s18
    v_perm_b32 v143, v95, v94, s18
    s_nop 1
    v_mfma_f32_32x32x16_bf16 v[160:175], v[52:55], v[140:143], v[160:175]
    s_waitcnt lgkmcnt(0)
    s_cmp_ge_u32 s16, 2
    s_cbranch_scc1 k2_kernel_nd_2
    s_mov_b32 m0, s22
    s_add_u32 s23, s22, 81920
    buffer_load_dwordx4 v7, s[8:11], s22 offen lds
    s_mov_b32 m0, s23
    s_add_u32 s22, s22, 8192
    buffer_load_dwordx4 v7, s[8:11], s23 offen lds
k2_kernel_nd_2:
    ds_read_b128 v[40:43], v4 offset:7680
    ds_read_b64 v[44:45], v5 offset:8704
    s_mov_b64 exec, s[14:15]
    ds_read_b128 v[48:51], v6 offset:6400
    ds_read_b128 v[52:55], v6 offset:7040
    s_mov_b64 exec, -1
    v_mfma_f32_32x32x16_bf16 v[64:79], v[32:35], v[16:19], 0
    v_exp_f32 v96, v96
    v_exp_f32 v97, v97
    v_exp_f32 v98, v98
    v_exp_f32 v99, v99
    v_mfma_f32_32x32x16_bf16 v[64:79], v[36:39], v[20:23], v[64:79]
    v_exp_f32 v100, v100
    v_exp_f32 v101, v101
    v_exp_f32 v102, v102
    v_exp_f32 v103, v103
    v_perm_b32 v128, v97, v96, s18
    v_perm_b32 v129, v99, v98, s18
    v_mfma_f32_32x32x16_bf16 v[80:95], v[32:35], v[24:27], 0
    v_exp_f32 v104, v104
    v_exp_f32 v105, v105
    v_exp_f32 v106, v106
    v_exp_f32 v107, v107
    v_perm_b32 v130, v101, v100, s18
    v_perm_b32 v131, v103, v102, s18
    v_mfma_f32_32x32x16_bf16 v[80:95], v[36:39], v[28:31], v[80:95]
    v_exp_f32 v108, v108
    v_exp_f32 v109, v109
    v_exp_f32 v110, v110
    v_exp_f32 v111, v111
    v_perm_b32 v132, v105, v104, s18
    v_perm_b32 v133, v107, v106, s18
    v_exp_f32 v112, v112
    v_exp_f32 v113, v113
    v_perm_b32 v134, v109, v108, s18
    v_perm_b32 v135, v111, v110, s18
    v_mfma_f32_32x32x16_bf16 v[144:159], v[56:59], v[128:131], v[144:159]
    v_exp_f32 v114, v114
    v_exp_f32 v115, v115
    v_exp_f32 v116, v116
    v_exp_f32 v117, v117
    v_mfma_f32_32x32x16_bf16 v[144:159], v[60:63], v[132:135], v[144:159]
    v_exp_f32 v118, v118
    v_exp_f32 v119, v119
    v_exp_f32 v120, v120
    v_exp_f32 v121, v121
    v_perm_b32 v136, v113, v112, s18
    v_perm_b32 v137, v115, v114, s18
    v_perm_b32 v138, v117, v116, s18
    v_perm_b32 v139, v119, v118, s18
    v_exp_f32 v122, v122
    v_exp_f32 v123, v123
    v_exp_f32 v124, v124
    v_mfma_f32_32x32x16_bf16 v[160:175], v[56:59], v[136:139], v[160:175]
    v_exp_f32 v125, v125
    v_exp_f32 v126, v126
    v_exp_f32 v127, v127
    v_perm_b32 v140, v121, v120, s18
    v_perm_b32 v141, v123, v122, s18
    v_perm_b32 v142, v125, v124, s18
    v_perm_b32 v143, v127, v126, s18
    s_nop 1
    v_mfma_f32_32x32x16_bf16 v[160:175], v[60:63], v[140:143], v[160:175]
    s_waitcnt lgkmcnt(0)
    s_cmp_ge_u32 s16, 2
    s_cbranch_scc1 k2_kernel_nd_3
    s_mov_b32 m0, s22
    s_add_u32 s23, s22, 81920
    buffer_load_dwordx4 v7, s[8:11], s22 offen lds
    s_mov_b32 m0, s23
    s_add_u32 s22, s22, 8192
    buffer_load_dwordx4 v7, s[8:11], s23 offen lds
k2_kernel_nd_3:
    ds_read_b128 v[32:35], v4 offset:10240
    ds_read_b64 v[36:37], v5 offset:11264
    s_mov_b64 exec, s[14:15]
    ds_read_b128 v[56:59], v6 offset:8960
    ds_read_b128 v[60:63], v6 offset:9600
    s_mov_b64 exec, -1
    v_mfma_f32_32x32x16_bf16 v[96:111], v[40:43], v[16:19], 0
    v_exp_f32 v64, v64
    v_exp_f32 v65, v65
    v_exp_f32 v66, v66
    v_exp_f32 v67, v67
    v_mfma_f32_32x32x16_bf16 v[96:111], v[44:47], v[20:23], v[96:111]
    v_exp_f32 v68, v68
    v_exp_f32 v69, v69
    v_exp_f32 v70, v70
    v_exp_f32 v71, v71
    v_perm_b32 v128, v65, v64, s18
    v_perm_b32 v129, v67, v66, s18
    v_mfma_f32_32x32x16_bf16 v[112:127], v[40:43], v[24:27], 0
    v_exp_f32 v72, v72
    v_exp_f32 v73, v73
    v_exp_f32 v74, v74
    v_exp_f32 v75, v75
    v_perm_b32 v130, v69, v68, s18
    v_perm_b32 v131, v71, v70, s18
    v_mfma_f32_32x32x16_bf16 v[112:127], v[44:47], v[28:31], v[112:127]
    v_exp_f32 v76, v76
    v_exp_f32 v77, v77
    v_exp_f32 v78, v78
    v_exp_f32 v79, v79
    v_perm_b32 v132, v73, v72, s18
    v_perm_b32 v133, v75, v74, s18
    v_exp_f32 v80, v80
    v_exp_f32 v81, v81
    v_perm_b32 v134, v77, v76, s18
    v_perm_b32 v135, v79, v78, s18
    v_mfma_f32_32x32x16_bf16 v[144:159], v[48:51], v[128:131], v[144:159]
    v_exp_f32 v82, v82
    v_exp_f32 v83, v83
    v_exp_f32 v84, v84
    v_exp_f32 v85, v85
    v_mfma_f32_32x32x16_bf16 v[144:159], v[52:55], v[132:135], v[144:159]
    v_exp_f32 v86, v86
    v_exp_f32 v87, v87
    v_exp_f32 v88, v88
    v_exp_f32 v89, v89
    v_perm_b32 v136, v81, v80, s18
    v_perm_b32 v137, v83, v82, s18
    v_perm_b32 v138, v85, v84, s18
    v_perm_b32 v139, v87, v86, s18
    v_exp_f32 v90, v90
    v_exp_f32 v91, v91
    v_exp_f32 v92, v92
    v_mfma_f32_32x32x16_bf16 v[160:175], v[48:51], v[136:139], v[160:175]
    v_exp_f32 v93, v93
    v_exp_f32 v94, v94
    v_exp_f32 v95, v95
    v_perm_b32 v140, v89, v88, s18
    v_perm_b32 v141, v91, v90, s18
    v_perm_b32 v142, v93, v92, s18
    v_perm_b32 v143, v95, v94, s18
    s_nop 1
    v_mfma_f32_32x32x16_bf16 v[160:175], v[52:55], v[140:143], v[160:175]
    s_waitcnt lgkmcnt(0)
    ds_read_b128 v[40:43], v4 offset:12800
    ds_read_b64 v[44:45], v5 offset:13824
    s_mov_b64 exec, s[14:15]
    ds_read_b128 v[48:51], v6 offset:11520
    ds_read_b128 v[52:55], v6 offset:12160
    s_mov_b64 exec, -1
    v_mfma_f32_32x32x16_bf16 v[64:79], v[32:35], v[16:19], 0
    v_exp_f32 v96, v96
    v_exp_f32 v97, v97
    v_exp_f32 v98, v98
    v_exp_f32 v99, v99
    v_mfma_f32_32x32x16_bf16 v[64:79], v[36:39], v[20:23], v[64:79]
    v_exp_f32 v100, v100
    v_exp_f32 v101, v101
    v_exp_f32 v102, v102
    v_exp_f32 v103, v103
    v_perm_b32 v128, v97, v96, s18
    v_perm_b32 v129, v99, v98, s18
    v_mfma_f32_32x32x16_bf16 v[80:95], v[32:35], v[24:27], 0
    v_exp_f32 v104, v104
    v_exp_f32 v105, v105
    v_exp_f32 v106, v106
    v_exp_f32 v107, v107
    v_perm_b32 v130, v101, v100, s18
    v_perm_b32 v131, v103, v102, s18
    v_mfma_f32_32x32x16_bf16 v[80:95], v[36:39], v[28:31], v[80:95]
    v_exp_f32 v108, v108
    v_exp_f32 v109, v109
    v_exp_f32 v110, v110
    v_exp_f32 v111, v111
    v_perm_b32 v132, v105, v104, s18
    v_perm_b32 v133, v107, v106, s18
    v_exp_f32 v112, v112
    v_exp_f32 v113, v113
    v_perm_b32 v134, v109, v108, s18
    v_perm_b32 v135, v111, v110, s18
    v_mfma_f32_32x32x16_bf16 v[144:159], v[56:59], v[128:131], v[144:159]
    v_exp_f32 v114, v114
    v_exp_f32 v115, v115
    v_exp_f32 v116, v116
    v_exp_f32 v117, v117
    v_mfma_f32_32x32x16_bf16 v[144:159], v[60:63], v[132:135], v[144:159]
    v_exp_f32 v118, v118
    v_exp_f32 v119, v119
    v_exp_f32 v120, v120
    v_exp_f32 v121, v121
    v_perm_b32 v136, v113, v112, s18
    v_perm_b32 v137, v115, v114, s18
    v_perm_b32 v138, v117, v116, s18
    v_perm_b32 v139, v119, v118, s18
    v_exp_f32 v122, v122
    v_exp_f32 v123, v123
    v_exp_f32 v124, v124
    v_mfma_f32_32x32x16_bf16 v[160:175], v[56:59], v[136:139], v[160:175]
    v_exp_f32 v125, v125
    v_exp_f32 v126, v126
    v_exp_f32 v127, v127
    v_perm_b32 v140, v121, v120, s18
    v_perm_b32 v141, v123, v122, s18
    v_perm_b32 v142, v125, v124, s18
    v_perm_b32 v143, v127, v126, s18
    v_add_u32 v4, 10240, v4
    v_add_u32 v5, 10240, v5
    v_add_u32 v6, 10240, v6
    s_add_u32 s16, s16, 1
    s_cmp_lt_u32 s16, 8
    v_mfma_f32_32x32x16_bf16 v[160:175], v[60:63], v[140:143], v[160:175]
    s_cbranch_scc1 k2_kernel_loop
    s_branch k2_kernel_merge
k2_kernel_slow:
    s_mov_b32 m0, s22
    s_add_u32 s23, s22, 81920
    buffer_load_dwordx4 v7, s[8:11], s22 offen lds
    s_mov_b32 m0, s23
    s_add_u32 s22, s22, 8192
    buffer_load_dwordx4 v7, s[8:11], s23 offen lds
    s_mov_b32 m0, s22
    s_add_u32 s23, s22, 81920
    buffer_load_dwordx4 v7, s[8:11], s22 offen lds
    s_mov_b32 m0, s23
    s_add_u32 s22, s22, 8192
    buffer_load_dwordx4 v7, s[8:11], s23 offen lds
    s_mov_b32 m0, s22
    s_add_u32 s23, s22, 81920
    buffer_load_dwordx4 v7, s[8:11], s22 offen lds
    s_mov_b32 m0, s23
    s_add_u32 s22, s22, 8192
    buffer_load_dwordx4 v7, s[8:11], s23 offen lds
    s_mov_b32 m0, s22
    s_add_u32 s23, s22, 81920
    buffer_load_dwordx4 v7, s[8:11], s22 offen lds
    s_mov_b32 m0, s23
    s_add_u32 s22, s22, 8192
    buffer_load_dwordx4 v7, s[8:11], s23 offen lds
    s_mov_b32 m0, s22
    s_add_u32 s23, s22, 81920
    buffer_load_dwordx4 v7, s[8:11], s22 offen lds
    s_mov_b32 m0, s23
    s_add_u32 s22, s22, 8192
    buffer_load_dwordx4 v7, s[8:11], s23 offen lds
    s_mov_b32 m0, s22
    s_add_u32 s23, s22, 81920
    buffer_load_dwordx4 v7, s[8:11], s22 offen lds
    s_mov_b32 m0, s23
    s_add_u32 s22, s22, 8192
    buffer_load_dwordx4 v7, s[8:11], s23 offen lds
    s_waitcnt vmcnt(0)
    s_barrier
    v_mov_b32 v176, 0xff61b1e6
    v_mov_b32 v177, 0xff61b1e6
    s_mov_b32 s16, 0
k2_kernel_sloop:
    ds_read_b128 v[32:35], v4 offset:0
    ds_read_b64 v[36:37], v5 offset:1024
    s_mov_b64 exec, s[14:15]
    ds_read_b128 v[48:51], v6 offset:1280
    ds_read_b128 v[52:55], v6 offset:1920
    s_mov_b64 exec, -1
    s_waitcnt lgkmcnt(0)
    v_mfma_f32_32x32x16_bf16 v[64:79], v[32:35], v[16:19], 0
    v_mfma_f32_32x32x16_bf16 v[64:79], v[36:39], v[20:23], v[64:79]
    v_mfma_f32_32x32x16_bf16 v[80:95], v[32:35], v[24:27], 0
    v_mfma_f32_32x32x16_bf16 v[80:95], v[36:39], v[28:31], v[80:95]
    s_nop 7
    s_nop 7
    v_max3_f32 v178, v64, v65, v66
    v_max3_f32 v178, v178, v67, v68
    v_max3_f32 v178, v178, v69, v70
    v_max3_f32 v178, v178, v71, v72
    v_max3_f32 v178, v178, v73, v74
    v_max3_f32 v178, v178, v75, v76
    v_max3_f32 v178, v178, v77, v78
    v_max_f32 v178, v178, v79
    v_mov_b32 v179, v178
    v_mov_b32 v180, v178
    s_nop 1
    v_permlane32_swap_b32 v179, v180
    s_nop 1
    v_max3_f32 v178, v179, v180, v176
    v_sub_f32 v179, v176, v178
    v_exp_f32 v179, v179
    v_mov_b32 v176, v178
    v_mul_f32 v144, v179, v144
    v_mul_f32 v145, v179, v145
    v_mul_f32 v146, v179, v146
    v_mul_f32 v147, v179, v147
    v_mul_f32 v148, v179, v148
    v_mul_f32 v149, v179, v149
    v_mul_f32 v150, v179, v150
    v_mul_f32 v151, v179, v151
    v_mul_f32 v152, v179, v152
    v_mul_f32 v153, v179, v153
    v_mul_f32 v154, v179, v154
    v_mul_f32 v155, v179, v155
    v_mul_f32 v156, v179, v156
    v_mul_f32 v157, v179, v157
    v_mul_f32 v158, v179, v158
    v_mul_f32 v159, v179, v159
    v_sub_f32 v64, v64, v178
    v_sub_f32 v65, v65, v178
    v_sub_f32 v66, v66, v178
    v_sub_f32 v67, v67, v178
    v_sub_f32 v68, v68, v178
    v_sub_f32 v69, v69, v178
    v_sub_f32 v70, v70, v178
    v_sub_f32 v71, v71, v178
    v_sub_f32 v72, v72, v178
    v_sub_f32 v73, v73, v178
    v_sub_f32 v74, v74, v178
    v_sub_f32 v75, v75, v178
    v_sub_f32 v76, v76, v178
    v_sub_f32 v77, v77, v178
    v_sub_f32 v78, v78, v178
    v_sub_f32 v79, v79, v178
    v_exp_f32 v64, v64
    v_exp_f32 v65, v65
    v_exp_f32 v66, v66
    v_exp_f32 v67, v67
    v_exp_f32 v68, v68
    v_exp_f32 v69, v69
    v_exp_f32 v70, v70
    v_exp_f32 v71, v71
    v_exp_f32 v72, v72
    v_exp_f32 v73, v73
    v_exp_f32 v74, v74
    v_exp_f32 v75, v75
    v_exp_f32 v76, v76
    v_exp_f32 v77, v77
    v_exp_f32 v78, v78
    v_exp_f32 v79, v79
    s_nop 0
    v_perm_b32 v128, v65, v64, s18
    v_perm_b32 v129, v67, v66, s18
    v_perm_b32 v130, v69, v68, s18
    v_perm_b32 v131, v71, v70, s18
    v_perm_b32 v132, v73, v72, s18
    v_perm_b32 v133, v75, v74, s18
    v_perm_b32 v134, v77, v76, s18
    v_perm_b32 v135, v79, v78, s18
    s_nop 1
    v_mfma_f32_32x32x16_bf16 v[144:159], v[48:51], v[128:131], v[144:159]
    v_mfma_f32_32x32x16_bf16 v[144:159], v[52:55], v[132:135], v[144:159]
    v_max3_f32 v178, v80, v81, v82
    v_max3_f32 v178, v178, v83, v84
    v_max3_f32 v178, v178, v85, v86
    v_max3_f32 v178, v178, v87, v88
    v_max3_f32 v178, v178, v89, v90
    v_max3_f32 v178, v178, v91, v92
    v_max3_f32 v178, v178, v93, v94
    v_max_f32 v178, v178, v95
    v_mov_b32 v179, v178
    v_mov_b32 v180, v178
    s_nop 1
    v_permlane32_swap_b32 v179, v180
    s_nop 1
    v_max3_f32 v178, v179, v180, v177
    v_sub_f32 v179, v177, v178
    v_exp_f32 v179, v179
    v_mov_b32 v177, v178
    v_mul_f32 v160, v179, v160
    v_mul_f32 v161, v179, v161
    v_mul_f32 v162, v179, v162
    v_mul_f32 v163, v179, v163
    v_mul_f32 v164, v179, v164
    v_mul_f32 v165, v179, v165
    v_mul_f32 v166, v179, v166
    v_mul_f32 v167, v179, v167
    v_mul_f32 v168, v179, v168
    v_mul_f32 v169, v179, v169
    v_mul_f32 v170, v179, v170
    v_mul_f32 v171, v179, v171
    v_mul_f32 v172, v179, v172
    v_mul_f32 v173, v179, v173
    v_mul_f32 v174, v179, v174
    v_mul_f32 v175, v179, v175
    v_sub_f32 v80, v80, v178
    v_sub_f32 v81, v81, v178
    v_sub_f32 v82, v82, v178
    v_sub_f32 v83, v83, v178
    v_sub_f32 v84, v84, v178
    v_sub_f32 v85, v85, v178
    v_sub_f32 v86, v86, v178
    v_sub_f32 v87, v87, v178
    v_sub_f32 v88, v88, v178
    v_sub_f32 v89, v89, v178
    v_sub_f32 v90, v90, v178
    v_sub_f32 v91, v91, v178
    v_sub_f32 v92, v92, v178
    v_sub_f32 v93, v93, v178
    v_sub_f32 v94, v94, v178
    v_sub_f32 v95, v95, v178
    v_exp_f32 v80, v80
    v_exp_f32 v81, v81
    v_exp_f32 v82, v82
    v_exp_f32 v83, v83
    v_exp_f32 v84, v84
    v_exp_f32 v85, v85
    v_exp_f32 v86, v86
    v_exp_f32 v87, v87
    v_exp_f32 v88, v88
    v_exp_f32 v89, v89
    v_exp_f32 v90, v90
    v_exp_f32 v91, v91
    v_exp_f32 v92, v92
    v_exp_f32 v93, v93
    v_exp_f32 v94, v94
    v_exp_f32 v95, v95
    s_nop 0
    v_perm_b32 v136, v81, v80, s18
    v_perm_b32 v137, v83, v82, s18
    v_perm_b32 v138, v85, v84, s18
    v_perm_b32 v139, v87, v86, s18
    v_perm_b32 v140, v89, v88, s18
    v_perm_b32 v141, v91, v90, s18
    v_perm_b32 v142, v93, v92, s18
    v_perm_b32 v143, v95, v94, s18
    s_nop 1
    v_mfma_f32_32x32x16_bf16 v[160:175], v[48:51], v[136:139], v[160:175]
    v_mfma_f32_32x32x16_bf16 v[160:175], v[52:55], v[140:143], v[160:175]
    s_nop 7
    s_nop 7
    v_add_u32 v4, 2560, v4
    v_add_u32 v5, 2560, v5
    v_add_u32 v6, 2560, v6
    s_add_u32 s16, s16, 1
    s_cmp_lt_u32 s16, 32
    s_cbranch_scc1 k2_kernel_sloop
k2_kernel_merge:
    s_nop 7
    s_nop 7
    s_waitcnt vmcnt(0) lgkmcnt(0)
    s_barrier
    s_lshl_b32 s17, s3, 12
    v_lshlrev_b32 v4, 4, v1
    v_add_u32 v5, s17, v4
    s_xor_b32 s17, s3, 4
    s_lshl_b32 s17, s17, 12
    v_add_u32 v6, s17, v4
    v_lshlrev_b32 v7, 2, v1
    v_add_u32 v8, s17, v7
    s_lshl_b32 s17, s3, 12
    v_add_u32 v7, s17, v7
    s_cmp_eq_u32 s13, 1
    s_cbranch_scc1 k2_kernel_mk1
    ds_write_b128 v5, v[160:163] offset:0
    ds_write_b128 v5, v[164:167] offset:1024
    ds_write_b128 v5, v[168:171] offset:2048
    ds_write_b32 v7, v177 offset:3072
    s_waitcnt lgkmcnt(0)
    s_barrier
    ds_read_b128 v[160:163], v6 offset:0
    ds_read_b128 v[164:167], v6 offset:1024
    ds_read_b128 v[168:171], v6 offset:2048
    ds_read_b32 v177, v8 offset:3072
    s_waitcnt lgkmcnt(0)
    v_max_f32 v178, v176, v177
    v_sub_f32 v179, v176, v178
    v_sub_f32 v180, v177, v178
    v_exp_f32 v179, v179
    v_exp_f32 v180, v180
    s_nop 0
    v_mul_f32 v144, v179, v144
    v_mul_f32 v145, v179, v145
    v_mul_f32 v146, v179, v146
    v_mul_f32 v147, v179, v147
    v_mul_f32 v148, v179, v148
    v_mul_f32 v149, v179, v149
    v_mul_f32 v150, v179, v150
    v_mul_f32 v151, v179, v151
    v_mul_f32 v152, v179, v152
    v_mul_f32 v153, v179, v153
    v_mul_f32 v154, v179, v154
    v_mul_f32 v155, v179, v155
    v_fma_f32 v144, v180, v160, v144
    v_fma_f32 v145, v180, v161, v145
    v_fma_f32 v146, v180, v162, v146
    v_fma_f32 v147, v180, v163, v147
    v_fma_f32 v148, v180, v164, v148
    v_fma_f32 v149, v180, v165, v149
    v_fma_f32 v150, v180, v166, v150
    v_fma_f32 v151, v180, v167, v151
    v_fma_f32 v152, v180, v168, v152
    v_fma_f32 v153, v180, v169, v153
    v_fma_f32 v154, v180, v170, v154
    v_fma_f32 v155, v180, v171, v155
    v_mov_b32 v179, v152
    v_mov_b32 v180, v152
    s_nop 1
    v_permlane32_swap_b32 v179, v180
    s_nop 1
    v_rcp_f32 v180, v180
    s_nop 0
    v_mul_f32 v144, v180, v144
    v_mul_f32 v145, v180, v145
    v_mul_f32 v146, v180, v146
    v_mul_f32 v147, v180, v147
    v_mul_f32 v148, v180, v148
    v_mul_f32 v149, v180, v149
    v_mul_f32 v150, v180, v150
    v_mul_f32 v151, v180, v151
    v_mul_f32 v152, v180, v152
    v_mul_f32 v153, v180, v153
    v_mul_f32 v154, v180, v154
    v_mul_f32 v155, v180, v155
    v_cvt_pk_bf16_f32 v182, v144, v145
    v_cvt_pk_bf16_f32 v183, v146, v147
    v_cvt_pk_bf16_f32 v184, v148, v149
    v_cvt_pk_bf16_f32 v185, v150, v151
    v_cvt_pk_bf16_f32 v186, v152, v153
    v_cvt_pk_bf16_f32 v187, v154, v155
    v_mul_u32_u24 v9, 40, v2
    v_lshl_add_u32 v9, v3, 3, v9
    v_add_u32 v9, s19, v9
    v_add_u32 v9, 0x300000, v9
    buffer_store_dwordx2 v[182:183], v9, s[8:11], 0 offen
    buffer_store_dwordx2 v[184:185], v9, s[8:11], 0 offen offset:16
    s_mov_b64 exec, s[20:21]
    buffer_store_dwordx2 v[186:187], v9, s[8:11], 0 offen offset:32
    s_mov_b64 exec, -1
    s_branch k2_kernel_end
k2_kernel_mk1:
    ds_write_b128 v5, v[144:147] offset:0
    ds_write_b128 v5, v[148:151] offset:1024
    ds_write_b128 v5, v[152:155] offset:2048
    ds_write_b32 v7, v176 offset:3072
    s_waitcnt lgkmcnt(0)
    s_barrier
    ds_read_b128 v[144:147], v6 offset:0
    ds_read_b128 v[148:151], v6 offset:1024
    ds_read_b128 v[152:155], v6 offset:2048
    ds_read_b32 v176, v8 offset:3072
    s_waitcnt lgkmcnt(0)
    v_max_f32 v178, v177, v176
    v_sub_f32 v179, v177, v178
    v_sub_f32 v180, v176, v178
    v_exp_f32 v179, v179
    v_exp_f32 v180, v180
    s_nop 0
    v_mul_f32 v160, v179, v160
    v_mul_f32 v161, v179, v161
    v_mul_f32 v162, v179, v162
    v_mul_f32 v163, v179, v163
    v_mul_f32 v164, v179, v164
    v_mul_f32 v165, v179, v165
    v_mul_f32 v166, v179, v166
    v_mul_f32 v167, v179, v167
    v_mul_f32 v168, v179, v168
    v_mul_f32 v169, v179, v169
    v_mul_f32 v170, v179, v170
    v_mul_f32 v171, v179, v171
    v_fma_f32 v160, v180, v144, v160
    v_fma_f32 v161, v180, v145, v161
    v_fma_f32 v162, v180, v146, v162
    v_fma_f32 v163, v180, v147, v163
    v_fma_f32 v164, v180, v148, v164
    v_fma_f32 v165, v180, v149, v165
    v_fma_f32 v166, v180, v150, v166
    v_fma_f32 v167, v180, v151, v167
    v_fma_f32 v168, v180, v152, v168
    v_fma_f32 v169, v180, v153, v169
    v_fma_f32 v170, v180, v154, v170
    v_fma_f32 v171, v180, v155, v171
    v_mov_b32 v179, v168
    v_mov_b32 v180, v168
    s_nop 1
    v_permlane32_swap_b32 v179, v180
    s_nop 1
    v_rcp_f32 v180, v180
    s_nop 0
    v_mul_f32 v160, v180, v160
    v_mul_f32 v161, v180, v161
    v_mul_f32 v162, v180, v162
    v_mul_f32 v163, v180, v163
    v_mul_f32 v164, v180, v164
    v_mul_f32 v165, v180, v165
    v_mul_f32 v166, v180, v166
    v_mul_f32 v167, v180, v167
    v_mul_f32 v168, v180, v168
    v_mul_f32 v169, v180, v169
    v_mul_f32 v170, v180, v170
    v_mul_f32 v171, v180, v171
    v_cvt_pk_bf16_f32 v182, v160, v161
    v_cvt_pk_bf16_f32 v183, v162, v163
    v_cvt_pk_bf16_f32 v184, v164, v165
    v_cvt_pk_bf16_f32 v185, v166, v167
    v_cvt_pk_bf16_f32 v186, v168, v169
    v_cvt_pk_bf16_f32 v187, v170, v171
    v_mul_u32_u24 v9, 40, v2
    v_lshl_add_u32 v9, v3, 3, v9
    v_add_u32 v9, s19, v9
    v_add_u32 v9, 0x300500, v9
    buffer_store_dwordx2 v[182:183], v9, s[8:11], 0 offen
    buffer_store_dwordx2 v[184:185], v9, s[8:11], 0 offen offset:16
    s_mov_b64 exec, s[20:21]
    buffer_store_dwordx2 v[186:187], v9, s[8:11], 0 offen offset:32
    s_mov_b64 exec, -1
k2_kernel_end:
k2_kernel_exit:
    s_endpgm
.section .rodata,"a"
.p2align 6
.amdhsa_kernel k2_kernel
  .amdhsa_next_free_vgpr 192
  .amdhsa_next_free_sgpr 56
  .amdhsa_accum_offset 192
  .amdhsa_group_segment_fixed_size 0
  .amdhsa_kernarg_size 104
  .amdhsa_user_sgpr_count 2
  .amdhsa_user_sgpr_kernarg_segment_ptr 1
  .amdhsa_system_sgpr_workgroup_id_x 1
.end_amdhsa_kernel

.text
.globl k3_kernel
.p2align 8
.type k3_kernel,@function
k3_kernel:
    s_cmp_ge_u32 s2, 256
    s_cbranch_scc1 k3_kernel_exit
    s_load_dwordx2 s[6:7], s[0:1], 32
    s_load_dwordx2 s[8:9], s[0:1], 0
    s_load_dwordx2 s[10:11], s[0:1], 48
    s_load_dwordx2 s[12:13], s[0:1], 96
    s_and_b32 s36, s2, 7
    s_lshr_b32 s37, s2, 6
    s_lshl_b32 s37, s37, 3
    s_add_u32 s36, s36, s37
    s_lshr_b32 s37, s2, 3
    s_and_b32 s37, s37, 7
    v_and_b32 v1, 63, v0
    v_and_b32 v2, 15, v0
    v_lshrrev_b32 v3, 4, v1
    v_lshrrev_b32 v5, 6, v0
    s_nop 0
    v_readfirstlane_b32 s3, v5
    s_lshl_b32 s38, s36, 6
    s_lshl_b32 s39, s3, 4
    s_add_u32 s38, s38, s39
    v_add_u32 v6, s38, v2
    v_lshrrev_b32 v7, 2, v1
    v_bfe_u32 v8, v1, 4, 2
    v_and_b32 v9, 3, v1
    v_xor_b32 v8, v8, v9
    v_add_u32 v7, s38, v7
    v_mul_u32_u24 v7, 1280, v7
    v_lshl_add_u32 v7, v8, 4, v7
    v_add_u32 v7, 0x300000, v7
    s_lshl_b32 s39, s3, 6
    v_add_u32 v8, s39, v1
    v_add_u32 v9, 256, v1
    s_mul_i32 s39, s37, 160
    v_mul_u32_u24 v10, 0x199a, v8
    v_lshrrev_b32 v10, 16, v10
    v_mul_u32_u24 v11, 10, v10
    v_sub_u32 v11, v8, v11
    v_mul_u32_u24 v10, 1280, v10
    v_lshl_add_u32 v10, v11, 4, v10
    v_add_u32 v8, s39, v10
    v_mul_u32_u24 v10, 0x199a, v9
    v_lshrrev_b32 v10, 16, v10
    v_mul_u32_u24 v11, 10, v10
    v_sub_u32 v11, v9, v11
    v_mul_u32_u24 v10, 1280, v10
    v_lshl_add_u32 v10, v11, 4, v10
    v_add_u32 v9, s39, v10
    v_lshlrev_b32 v10, 4, v1
    s_mul_i32 s39, s38, 1280
    v_lshlrev_b32 v11, 7, v1
    v_add_u32 v11, s39, v11
    v_add_u32 v11, 0x300000, v11
    s_waitcnt lgkmcnt(0)
    s_mov_b32 s28, s12
    s_and_b32 s29, s13, 0xffff
    s_mov_b32 s30, 0x1400000
    s_mov_b32 s31, 0x00020000
    s_mov_b32 s16, s12
    s_and_b32 s17, s13, 0xffff
    s_mov_b32 s18, 0x1400000
    s_mov_b32 s19, 0x00020000
    s_mov_b32 s20, s6
    s_and_b32 s21, s7, 0xffff
    s_mov_b32 s22, 0xc8000
    s_mov_b32 s23, 0x00020000
    s_mov_b32 s24, s8
    s_and_b32 s25, s9, 0xffff
    s_mov_b32 s26, 0x280000
    s_mov_b32 s27, 0x00020000
    s_mov_b32 s32, s10
    s_and_b32 s33, s11, 0xffff
    s_mov_b32 s34, 0x500
    s_mov_b32 s35, 0x00020000
    s_mul_i32 s43, s3, 12288
    s_add_u32 s43, s43, 61440
    s_lshl_b32 s45, s3, 10
    s_mul_i32 s46, s3, 5120
    s_mul_i32 s47, s3, 40960
    v_mul_u32_u24 v12, 1280, v6
    s_mul_i32 s39, s37, 160
    v_lshl_add_u32 v13, v3, 3, s39
    v_add_u32 v12, v12, v13
    s_add_u32 s40, s43, 0
    s_mov_b32 m0, s40
    s_movk_i32 s41, 0
    buffer_load_dwordx4 v7, s[16:19], s41 offen lds
    s_add_u32 s40, s43, 1024
    s_mov_b32 m0, s40
    s_movk_i32 s41, 64
    buffer_load_dwordx4 v7, s[16:19], s41 offen lds
    s_add_u32 s40, s43, 2048
    s_mov_b32 m0, s40
    s_movk_i32 s41, 128
    buffer_load_dwordx4 v7, s[16:19], s41 offen lds
    s_add_u32 s40, s43, 3072
    s_mov_b32 m0, s40
    s_movk_i32 s41, 192
    buffer_load_dwordx4 v7, s[16:19], s41 offen lds
    s_add_u32 s40, s45, 0
    s_mov_b32 m0, s40
    s_mov_b32 s41, 0
    buffer_load_dwordx4 v8, s[20:23], s41 offen lds
    s_add_u32 s40, s45, 5120
    s_mov_b32 m0, s40
    s_mov_b32 s41, 40960
    buffer_load_dwordx4 v8, s[20:23], s41 offen lds
    s_add_u32 s40, s45, 10240
    s_mov_b32 m0, s40
    s_mov_b32 s41, 81920
    buffer_load_dwordx4 v8, s[20:23], s41 offen lds
    s_add_u32 s40, s45, 15360
    s_mov_b32 m0, s40
    s_mov_b32 s41, 122880
    buffer_load_dwordx4 v8, s[20:23], s41 offen lds
    s_add_u32 s40, s46, 4096
    s_mov_b32 m0, s40
    s_add_u32 s41, s47, 0
    buffer_load_dwordx4 v9, s[20:23], s41 offen lds
    s_add_u32 s40, s43, 4096
    s_mov_b32 m0, s40
    s_movk_i32 s41, 256
    buffer_load_dwordx4 v7, s[16:19], s41 offen lds
    s_add_u32 s40, s43, 5120
    s_mov_b32 m0, s40
    s_movk_i32 s41, 320
    buffer_load_dwordx4 v7, s[16:19], s41 offen lds
    s_add_u32 s40, s43, 6144
    s_mov_b32 m0, s40
    s_movk_i32 s41, 384
    buffer_load_dwordx4 v7, s[16:19], s41 offen lds
    s_add_u32 s40, s43, 7168
    s_mov_b32 m0, s40
    s_movk_i32 s41, 448
    buffer_load_dwordx4 v7, s[16:19], s41 offen lds
    s_add_u32 s40, s45, 20480
    s_mov_b32 m0, s40
    s_mov_b32 s41, 163840
    buffer_load_dwordx4 v8, s[20:23], s41 offen lds
    s_add_u32 s40, s45, 25600
    s_mov_b32 m0, s40
    s_mov_b32 s41, 204800
    buffer_load_dwordx4 v8, s[20:23], s41 offen lds
    s_add_u32 s40, s45, 30720
    s_mov_b32 m0, s40
    s_mov_b32 s41, 245760
    buffer_load_dwordx4 v8, s[20:23], s41 offen lds
    s_add_u32 s40, s45, 35840
    s_mov_b32 m0, s40
    s_mov_b32 s41, 286720
    buffer_load_dwordx4 v8, s[20:23], s41 offen lds
    s_add_u32 s40, s46, 24576
    s_mov_b32 m0, s40
    s_add_u32 s41, s47, 163840
    buffer_load_dwordx4 v9, s[20:23], s41 offen lds
    v_lshrrev_b32 v14, 2, v2
    v_and_b32 v15, 3, v2
    v_lshl_add_u32 v14, v3, 2, v14
    v_mul_u32_u24 v176, 40, v14
    v_lshl_add_u32 v176, v15, 3, v176
    s_and_b32 s40, s37, 1
    s_lshl_b32 s40, s40, 5
    s_add_u32 s40, s40, 110592
    v_add_u32 v176, s40, v176
    v_mul_u32_u24 v14, 160, v14
    v_lshl_add_u32 v14, v15, 3, v14
    v_add_u32 v15, 61440, v14
    v_mov_b32 v4, v176
    v_lshrrev_b32 v176, 1, v3
    v_lshrrev_b32 v177, 2, v2
    v_xor_b32 v176, v176, v177
    v_xor_b32 v177, 2, v176
    v_and_b32 v178, 1, v3
    v_lshlrev_b32 v178, 3, v178
    v_lshl_add_u32 v178, v2, 6, v178
    v_add_u32 v178, s43, v178
    v_lshl_add_u32 v10, v176, 4, v178
    v_lshl_add_u32 v11, v177, 4, v178
    v_mov_b32 v144, 0x3f803f80
    v_mov_b32 v145, 0x3f803f80
    v_mov_b32 v146, 0x3f803f80
    v_mov_b32 v147, 0x3f803f80
    s_waitcnt vmcnt(9)
    s_barrier
    ds_read_b64 v[72:73], v10 offset:0
    ds_read_b64 v[74:75], v11 offset:0
    ds_read_b64_tr_b16 v[16:17], v14 offset:0
    ds_read_b64_tr_b16 v[18:19], v14 offset:2560
    ds_read_b64_tr_b16 v[20:21], v14 offset:32
    ds_read_b64_tr_b16 v[22:23], v14 offset:2592
    ds_read_b64_tr_b16 v[24:25], v14 offset:64
    ds_read_b64_tr_b16 v[26:27], v14 offset:2624
    ds_read_b64_tr_b16 v[28:29], v14 offset:96
    ds_read_b64_tr_b16 v[30:31], v14 offset:2656
    ds_read_b64_tr_b16 v[32:33], v14 offset:128
    ds_read_b64_tr_b16 v[34:35], v14 offset:2688
    s_waitcnt lgkmcnt(0)
    s_add_u32 s40, s43, 8192
    s_mov_b32 m0, s40
    s_movk_i32 s41, 512
    buffer_load_dwordx4 v7, s[16:19], s41 offen lds
    s_add_u32 s40, s43, 9216
    s_mov_b32 m0, s40
    s_movk_i32 s41, 576
    buffer_load_dwordx4 v7, s[16:19], s41 offen lds
    s_add_u32 s40, s43, 10240
    s_mov_b32 m0, s40
    s_movk_i32 s41, 640
    buffer_load_dwordx4 v7, s[16:19], s41 offen lds
    ds_read_b64 v[76:77], v10 offset:1024
    ds_read_b64 v[78:79], v11 offset:1024
    ds_read_b64_tr_b16 v[36:37], v14 offset:5120
    ds_read_b64_tr_b16 v[38:39], v14 offset:7680
    ds_read_b64_tr_b16 v[40:41], v14 offset:5152
    ds_read_b64_tr_b16 v[42:43], v14 offset:7712
    ds_read_b64_tr_b16 v[44:45], v14 offset:5184
    ds_read_b64_tr_b16 v[46:47], v14 offset:7744
    ds_read_b64_tr_b16 v[48:49], v14 offset:5216
    ds_read_b64_tr_b16 v[50:51], v14 offset:7776
    ds_read_b64_tr_b16 v[52:53], v14 offset:5248
    ds_read_b64_tr_b16 v[54:55], v14 offset:7808
    v_mfma_f32_16x16x32_bf16 v[80:83], v[16:19], v[72:75], 0
    v_mfma_f32_16x16x32_bf16 v[84:87], v[20:23], v[72:75], 0
    v_mfma_f32_16x16x32_bf16 v[88:91], v[24:27], v[72:75], 0
    v_mfma_f32_16x16x32_bf16 v[92:95], v[28:31], v[72:75], 0
    v_mfma_f32_16x16x32_bf16 v[96:99], v[32:35], v[72:75], 0
    s_waitcnt lgkmcnt(0)
    s_add_u32 s40, s43, 11264
    s_mov_b32 m0, s40
    s_movk_i32 s41, 704
    buffer_load_dwordx4 v7, s[16:19], s41 offen lds
    s_add_u32 s40, s45, 40960
    s_mov_b32 m0, s40
    s_mov_b32 s41, 327680
    buffer_load_dwordx4 v8, s[20:23], s41 offen lds
    ds_read_b64 v[72:73], v10 offset:2048
    ds_read_b64 v[74:75], v11 offset:2048
    ds_read_b64_tr_b16 v[16:17], v14 offset:10240
    ds_read_b64_tr_b16 v[18:19], v14 offset:12800
    ds_read_b64_tr_b16 v[20:21], v14 offset:10272
    ds_read_b64_tr_b16 v[22:23], v14 offset:12832
    ds_read_b64_tr_b16 v[24:25], v14 offset:10304
    ds_read_b64_tr_b16 v[26:27], v14 offset:12864
    ds_read_b64_tr_b16 v[28:29], v14 offset:10336
    ds_read_b64_tr_b16 v[30:31], v14 offset:12896
    ds_read_b64_tr_b16 v[32:33], v14 offset:10368
    ds_read_b64_tr_b16 v[34:35], v14 offset:12928
    v_mfma_f32_16x16x32_bf16 v[80:83], v[36:39], v[76:79], v[80:83]
    v_mfma_f32_16x16x32_bf16 v[84:87], v[40:43], v[76:79], v[84:87]
    v_mfma_f32_16x16x32_bf16 v[88:91], v[44:47], v[76:79], v[88:91]
    v_mfma_f32_16x16x32_bf16 v[92:95], v[48:51], v[76:79], v[92:95]
    v_mfma_f32_16x16x32_bf16 v[96:99], v[52:55], v[76:79], v[96:99]
    s_waitcnt lgkmcnt(0)
    s_add_u32 s40, s45, 46080
    s_mov_b32 m0, s40
    s_mov_b32 s41, 368640
    buffer_load_dwordx4 v8, s[20:23], s41 offen lds
    s_add_u32 s40, s45, 51200
    s_mov_b32 m0, s40
    s_mov_b32 s41, 409600
    buffer_load_dwordx4 v8, s[20:23], s41 offen lds
    ds_read_b64 v[76:77], v10 offset:3072
    ds_read_b64 v[78:79], v11 offset:3072
    ds_read_b64_tr_b16 v[36:37], v14 offset:15360
    ds_read_b64_tr_b16 v[38:39], v14 offset:17920
    ds_read_b64_tr_b16 v[40:41], v14 offset:15392
    ds_read_b64_tr_b16 v[42:43], v14 offset:17952
    ds_read_b64_tr_b16 v[44:45], v14 offset:15424
    ds_read_b64_tr_b16 v[46:47], v14 offset:17984
    ds_read_b64_tr_b16 v[48:49], v14 offset:15456
    ds_read_b64_tr_b16 v[50:51], v14 offset:18016
    ds_read_b64_tr_b16 v[52:53], v14 offset:15488
    ds_read_b64_tr_b16 v[54:55], v14 offset:18048
    v_mfma_f32_16x16x32_bf16 v[80:83], v[16:19], v[72:75], v[80:83]
    v_mfma_f32_16x16x32_bf16 v[84:87], v[20:23], v[72:75], v[84:87]
    v_mfma_f32_16x16x32_bf16 v[88:91], v[24:27], v[72:75], v[88:91]
    v_mfma_f32_16x16x32_bf16 v[92:95], v[28:31], v[72:75], v[92:95]
    v_mfma_f32_16x16x32_bf16 v[96:99], v[32:35], v[72:75], v[96:99]
    s_waitcnt lgkmcnt(0)
    s_waitcnt vmcnt(7)
    s_barrier
    s_add_u32 s40, s45, 56320
    s_mov_b32 m0, s40
    s_mov_b32 s41, 450560
    buffer_load_dwordx4 v8, s[20:23], s41 offen lds
    s_add_u32 s40, s46, 45056
    s_mov_b32 m0, s40
    s_add_u32 s41, s47, 327680
    buffer_load_dwordx4 v9, s[20:23], s41 offen lds
    ds_read_b64 v[72:73], v10 offset:4096
    ds_read_b64 v[74:75], v11 offset:4096
    ds_read_b64_tr_b16 v[16:17], v14 offset:20480
    ds_read_b64_tr_b16 v[18:19], v14 offset:23040
    ds_read_b64_tr_b16 v[20:21], v14 offset:20512
    ds_read_b64_tr_b16 v[22:23], v14 offset:23072
    ds_read_b64_tr_b16 v[24:25], v14 offset:20544
    ds_read_b64_tr_b16 v[26:27], v14 offset:23104
    ds_read_b64_tr_b16 v[28:29], v14 offset:20576
    ds_read_b64_tr_b16 v[30:31], v14 offset:23136
    ds_read_b64_tr_b16 v[32:33], v14 offset:20608
    ds_read_b64_tr_b16 v[34:35], v14 offset:23168
    v_mfma_f32_16x16x32_bf16 v[80:83], v[36:39], v[76:79], v[80:83]
    v_mfma_f32_16x16x32_bf16 v[84:87], v[40:43], v[76:79], v[84:87]
    v_mfma_f32_16x16x32_bf16 v[88:91], v[44:47], v[76:79], v[88:91]
    v_mfma_f32_16x16x32_bf16 v[92:95], v[48:51], v[76:79], v[92:95]
    v_mfma_f32_16x16x32_bf16 v[96:99], v[52:55], v[76:79], v[96:99]
    s_waitcnt lgkmcnt(0)
    s_add_u32 s40, s43, 0
    s_mov_b32 m0, s40
    s_movk_i32 s41, 768
    buffer_load_dwordx4 v7, s[16:19], s41 offen lds
    s_add_u32 s40, s43, 1024
    s_mov_b32 m0, s40
    s_movk_i32 s41, 832
    buffer_load_dwordx4 v7, s[16:19], s41 offen lds
    s_add_u32 s40, s43, 2048
    s_mov_b32 m0, s40
    s_movk_i32 s41, 896
    buffer_load_dwordx4 v7, s[16:19], s41 offen lds
    ds_read_b64 v[76:77], v10 offset:5120
    ds_read_b64 v[78:79], v11 offset:5120
    ds_read_b64_tr_b16 v[36:37], v14 offset:25600
    ds_read_b64_tr_b16 v[38:39], v14 offset:28160
    ds_read_b64_tr_b16 v[40:41], v14 offset:25632
    ds_read_b64_tr_b16 v[42:43], v14 offset:28192
    ds_read_b64_tr_b16 v[44:45], v14 offset:25664
    ds_read_b64_tr_b16 v[46:47], v14 offset:28224
    ds_read_b64_tr_b16 v[48:49], v14 offset:25696
    ds_read_b64_tr_b16 v[50:51], v14 offset:28256
    ds_read_b64_tr_b16 v[52:53], v14 offset:25728
    ds_read_b64_tr_b16 v[54:55], v14 offset:28288
    v_mfma_f32_16x16x32_bf16 v[80:83], v[16:19], v[72:75], v[80:83]
    v_mfma_f32_16x16x32_bf16 v[84:87], v[20:23], v[72:75], v[84:87]
    v_mfma_f32_16x16x32_bf16 v[88:91], v[24:27], v[72:75], v[88:91]
    v_mfma_f32_16x16x32_bf16 v[92:95], v[28:31], v[72:75], v[92:95]
    v_mfma_f32_16x16x32_bf16 v[96:99], v[32:35], v[72:75], v[96:99]
    s_waitcnt lgkmcnt(0)
    s_add_u32 s40, s43, 3072
    s_mov_b32 m0, s40
    s_movk_i32 s41, 960
    buffer_load_dwordx4 v7, s[16:19], s41 offen lds
    s_add_u32 s40, s45, 0
    s_mov_b32 m0, s40
    s_mov_b32 s41, 491520
    buffer_load_dwordx4 v8, s[20:23], s41 offen lds
    ds_read_b64 v[72:73], v10 offset:6144
    ds_read_b64 v[74:75], v11 offset:6144
    ds_read_b64_tr_b16 v[16:17], v14 offset:30720
    ds_read_b64_tr_b16 v[18:19], v14 offset:33280
    ds_read_b64_tr_b16 v[20:21], v14 offset:30752
    ds_read_b64_tr_b16 v[22:23], v14 offset:33312
    ds_read_b64_tr_b16 v[24:25], v14 offset:30784
    ds_read_b64_tr_b16 v[26:27], v14 offset:33344
    ds_read_b64_tr_b16 v[28:29], v14 offset:30816
    ds_read_b64_tr_b16 v[30:31], v14 offset:33376
    ds_read_b64_tr_b16 v[32:33], v14 offset:30848
    ds_read_b64_tr_b16 v[34:35], v14 offset:33408
    v_mfma_f32_16x16x32_bf16 v[80:83], v[36:39], v[76:79], v[80:83]
    v_mfma_f32_16x16x32_bf16 v[84:87], v[40:43], v[76:79], v[84:87]
    v_mfma_f32_16x16x32_bf16 v[88:91], v[44:47], v[76:79], v[88:91]
    v_mfma_f32_16x16x32_bf16 v[92:95], v[48:51], v[76:79], v[92:95]
    v_mfma_f32_16x16x32_bf16 v[96:99], v[52:55], v[76:79], v[96:99]
    s_waitcnt lgkmcnt(0)
    s_add_u32 s40, s45, 5120
    s_mov_b32 m0, s40
    s_mov_b32 s41, 532480
    buffer_load_dwordx4 v8, s[20:23], s41 offen lds
    s_add_u32 s40, s45, 10240
    s_mov_b32 m0, s40
    s_mov_b32 s41, 573440
    buffer_load_dwordx4 v8, s[20:23], s41 offen lds
    ds_read_b64 v[76:77], v10 offset:7168
    ds_read_b64 v[78:79], v11 offset:7168
    ds_read_b64_tr_b16 v[36:37], v14 offset:35840
    ds_read_b64_tr_b16 v[38:39], v14 offset:38400
    ds_read_b64_tr_b16 v[40:41], v14 offset:35872
    ds_read_b64_tr_b16 v[42:43], v14 offset:38432
    ds_read_b64_tr_b16 v[44:45], v14 offset:35904
    ds_read_b64_tr_b16 v[46:47], v14 offset:38464
    ds_read_b64_tr_b16 v[48:49], v14 offset:35936
    ds_read_b64_tr_b16 v[50:51], v14 offset:38496
    ds_read_b64_tr_b16 v[52:53], v14 offset:35968
    ds_read_b64_tr_b16 v[54:55], v14 offset:38528
    v_mfma_f32_16x16x32_bf16 v[80:83], v[16:19], v[72:75], v[80:83]
    v_mfma_f32_16x16x32_bf16 v[84:87], v[20:23], v[72:75], v[84:87]
    v_mfma_f32_16x16x32_bf16 v[88:91], v[24:27], v[72:75], v[88:91]
    v_mfma_f32_16x16x32_bf16 v[92:95], v[28:31], v[72:75], v[92:95]
    v_mfma_f32_16x16x32_bf16 v[96:99], v[32:35], v[72:75], v[96:99]
    s_waitcnt lgkmcnt(0)
    s_waitcnt vmcnt(7)
    s_barrier
    s_add_u32 s40, s45, 15360
    s_mov_b32 m0, s40
    s_mov_b32 s41, 614400
    buffer_load_dwordx4 v8, s[20:23], s41 offen lds
    s_add_u32 s40, s46, 4096
    s_mov_b32 m0, s40
    s_add_u32 s41, s47, 491520
    buffer_load_dwordx4 v9, s[20:23], s41 offen lds
    ds_read_b64 v[72:73], v10 offset:8192
    ds_read_b64 v[74:75], v11 offset:8192
    ds_read_b64_tr_b16 v[16:17], v14 offset:40960
    ds_read_b64_tr_b16 v[18:19], v14 offset:43520
    ds_read_b64_tr_b16 v[20:21], v14 offset:40992
    ds_read_b64_tr_b16 v[22:23], v14 offset:43552
    ds_read_b64_tr_b16 v[24:25], v14 offset:41024
    ds_read_b64_tr_b16 v[26:27], v14 offset:43584
    ds_read_b64_tr_b16 v[28:29], v14 offset:41056
    ds_read_b64_tr_b16 v[30:31], v14 offset:43616
    ds_read_b64_tr_b16 v[32:33], v14 offset:41088
    ds_read_b64_tr_b16 v[34:35], v14 offset:43648
    v_mfma_f32_16x16x32_bf16 v[80:83], v[36:39], v[76:79], v[80:83]
    v_mfma_f32_16x16x32_bf16 v[84:87], v[40:43], v[76:79], v[84:87]
    v_mfma_f32_16x16x32_bf16 v[88:91], v[44:47], v[76:79], v[88:91]
    v_mfma_f32_16x16x32_bf16 v[92:95], v[48:51], v[76:79], v[92:95]
    v_mfma_f32_16x16x32_bf16 v[96:99], v[52:55], v[76:79], v[96:99]
    s_waitcnt lgkmcnt(0)
    s_add_u32 s40, s43, 4096
    s_mov_b32 m0, s40
    s_movk_i32 s41, 1024
    buffer_load_dwordx4 v7, s[16:19], s41 offen lds
    s_add_u32 s40, s43, 5120
    s_mov_b32 m0, s40
    s_movk_i32 s41, 1088
    buffer_load_dwordx4 v7, s[16:19], s41 offen lds
    s_add_u32 s40, s43, 6144
    s_mov_b32 m0, s40
    s_movk_i32 s41, 1152
    buffer_load_dwordx4 v7, s[16:19], s41 offen lds
    ds_read_b64 v[76:77], v10 offset:9216
    ds_read_b64 v[78:79], v11 offset:9216
    ds_read_b64_tr_b16 v[36:37], v14 offset:46080
    ds_read_b64_tr_b16 v[38:39], v14 offset:48640
    ds_read_b64_tr_b16 v[40:41], v14 offset:46112
    ds_read_b64_tr_b16 v[42:43], v14 offset:48672
    ds_read_b64_tr_b16 v[44:45], v14 offset:46144
    ds_read_b64_tr_b16 v[46:47], v14 offset:48704
    ds_read_b64_tr_b16 v[48:49], v14 offset:46176
    ds_read_b64_tr_b16 v[50:51], v14 offset:48736
    ds_read_b64_tr_b16 v[52:53], v14 offset:46208
    ds_read_b64_tr_b16 v[54:55], v14 offset:48768
    v_mfma_f32_16x16x32_bf16 v[80:83], v[16:19], v[72:75], v[80:83]
    v_mfma_f32_16x16x32_bf16 v[84:87], v[20:23], v[72:75], v[84:87]
    v_mfma_f32_16x16x32_bf16 v[88:91], v[24:27], v[72:75], v[88:91]
    v_mfma_f32_16x16x32_bf16 v[92:95], v[28:31], v[72:75], v[92:95]
    v_mfma_f32_16x16x32_bf16 v[96:99], v[32:35], v[72:75], v[96:99]
    s_waitcnt lgkmcnt(0)
    s_add_u32 s40, s43, 7168
    s_mov_b32 m0, s40
    s_movk_i32 s41, 1216
    buffer_load_dwordx4 v7, s[16:19], s41 offen lds
    s_add_u32 s40, s45, 20480
    s_mov_b32 m0, s40
    s_mov_b32 s41, 655360
    buffer_load_dwordx4 v8, s[20:23], s41 offen lds
    ds_read_b64 v[72:73], v10 offset:10240
    ds_read_b64 v[74:75], v11 offset:10240
    ds_read_b64_tr_b16 v[16:17], v14 offset:51200
    ds_read_b64_tr_b16 v[18:19], v14 offset:53760
    ds_read_b64_tr_b16 v[20:21], v14 offset:51232
    ds_read_b64_tr_b16 v[22:23], v14 offset:53792
    ds_read_b64_tr_b16 v[24:25], v14 offset:51264
    ds_read_b64_tr_b16 v[26:27], v14 offset:53824
    ds_read_b64_tr_b16 v[28:29], v14 offset:51296
    ds_read_b64_tr_b16 v[30:31], v14 offset:53856
    ds_read_b64_tr_b16 v[32:33], v14 offset:51328
    ds_read_b64_tr_b16 v[34:35], v14 offset:53888
    v_mfma_f32_16x16x32_bf16 v[80:83], v[36:39], v[76:79], v[80:83]
    v_mfma_f32_16x16x32_bf16 v[84:87], v[40:43], v[76:79], v[84:87]
    v_mfma_f32_16x16x32_bf16 v[88:91], v[44:47], v[76:79], v[88:91]
    v_mfma_f32_16x16x32_bf16 v[92:95], v[48:51], v[76:79], v[92:95]
    v_mfma_f32_16x16x32_bf16 v[96:99], v[52:55], v[76:79], v[96:99]
    s_waitcnt lgkmcnt(0)
    s_add_u32 s40, s45, 25600
    s_mov_b32 m0, s40
    s_mov_b32 s41, 696320
    buffer_load_dwordx4 v8, s[20:23], s41 offen lds
    s_add_u32 s40, s45, 30720
    s_mov_b32 m0, s40
    s_mov_b32 s41, 737280
    buffer_load_dwordx4 v8, s[20:23], s41 offen lds
    ds_read_b64 v[76:77], v10 offset:11264
    ds_read_b64 v[78:79], v11 offset:11264
    ds_read_b64_tr_b16 v[36:37], v14 offset:56320
    ds_read_b64_tr_b16 v[38:39], v14 offset:58880
    ds_read_b64_tr_b16 v[40:41], v14 offset:56352
    ds_read_b64_tr_b16 v[42:43], v14 offset:58912
    ds_read_b64_tr_b16 v[44:45], v14 offset:56384
    ds_read_b64_tr_b16 v[46:47], v14 offset:58944
    ds_read_b64_tr_b16 v[48:49], v14 offset:56416
    ds_read_b64_tr_b16 v[50:51], v14 offset:58976
    ds_read_b64_tr_b16 v[52:53], v14 offset:56448
    ds_read_b64_tr_b16 v[54:55], v14 offset:59008
    v_mfma_f32_16x16x32_bf16 v[80:83], v[16:19], v[72:75], v[80:83]
    v_mfma_f32_16x16x32_bf16 v[84:87], v[20:23], v[72:75], v[84:87]
    v_mfma_f32_16x16x32_bf16 v[88:91], v[24:27], v[72:75], v[88:91]
    v_mfma_f32_16x16x32_bf16 v[92:95], v[28:31], v[72:75], v[92:95]
    v_mfma_f32_16x16x32_bf16 v[96:99], v[32:35], v[72:75], v[96:99]
    s_waitcnt lgkmcnt(0)
    s_waitcnt vmcnt(7)
    s_barrier
    s_add_u32 s40, s45, 35840
    s_mov_b32 m0, s40
    s_mov_b32 s41, 778240
    buffer_load_dwordx4 v8, s[20:23], s41 offen lds
    s_add_u32 s40, s46, 24576
    s_mov_b32 m0, s40
    s_add_u32 s41, s47, 655360
    buffer_load_dwordx4 v9, s[20:23], s41 offen lds
    ds_read_b64 v[72:73], v10 offset:0
    ds_read_b64 v[74:75], v11 offset:0
    ds_read_b64_tr_b16 v[16:17], v14 offset:0
    ds_read_b64_tr_b16 v[18:19], v14 offset:2560
    ds_read_b64_tr_b16 v[20:21], v14 offset:32
    ds_read_b64_tr_b16 v[22:23], v14 offset:2592
    ds_read_b64_tr_b16 v[24:25], v14 offset:64
    ds_read_b64_tr_b16 v[26:27], v14 offset:2624
    ds_read_b64_tr_b16 v[28:29], v14 offset:96
    ds_read_b64_tr_b16 v[30:31], v14 offset:2656
    ds_read_b64_tr_b16 v[32:33], v14 offset:128
    ds_read_b64_tr_b16 v[34:35], v14 offset:2688
    v_mfma_f32_16x16x32_bf16 v[80:83], v[36:39], v[76:79], v[80:83]
    v_mfma_f32_16x16x32_bf16 v[84:87], v[40:43], v[76:79], v[84:87]
    v_mfma_f32_16x16x32_bf16 v[88:91], v[44:47], v[76:79], v[88:91]
    v_mfma_f32_16x16x32_bf16 v[92:95], v[48:51], v[76:79], v[92:95]
    v_mfma_f32_16x16x32_bf16 v[96:99], v[52:55], v[76:79], v[96:99]
    s_waitcnt lgkmcnt(0)
    ds_read_b64 v[76:77], v10 offset:1024
    ds_read_b64 v[78:79], v11 offset:1024
    ds_read_b64_tr_b16 v[36:37], v14 offset:5120
    ds_read_b64_tr_b16 v[38:39], v14 offset:7680
    ds_read_b64_tr_b16 v[40:41], v14 offset:5152
    ds_read_b64_tr_b16 v[42:43], v14 offset:7712
    ds_read_b64_tr_b16 v[44:45], v14 offset:5184
    ds_read_b64_tr_b16 v[46:47], v14 offset:7744
    ds_read_b64_tr_b16 v[48:49], v14 offset:5216
    ds_read_b64_tr_b16 v[50:51], v14 offset:7776
    ds_read_b64_tr_b16 v[52:53], v14 offset:5248
    ds_read_b64_tr_b16 v[54:55], v14 offset:7808
    v_mfma_f32_16x16x32_bf16 v[80:83], v[16:19], v[72:75], v[80:83]
    v_mfma_f32_16x16x32_bf16 v[84:87], v[20:23], v[72:75], v[84:87]
    v_mfma_f32_16x16x32_bf16 v[88:91], v[24:27], v[72:75], v[88:91]
    v_mfma_f32_16x16x32_bf16 v[92:95], v[28:31], v[72:75], v[92:95]
    v_mfma_f32_16x16x32_bf16 v[96:99], v[32:35], v[72:75], v[96:99]
    s_waitcnt lgkmcnt(0)
    ds_read_b64 v[72:73], v10 offset:2048
    ds_read_b64 v[74:75], v11 offset:2048
    ds_read_b64_tr_b16 v[16:17], v14 offset:10240
    ds_read_b64_tr_b16 v[18:19], v14 offset:12800
    ds_read_b64_tr_b16 v[20:21], v14 offset:10272
    ds_read_b64_tr_b16 v[22:23], v14 offset:12832
    ds_read_b64_tr_b16 v[24:25], v14 offset:10304
    ds_read_b64_tr_b16 v[26:27], v14 offset:12864
    ds_read_b64_tr_b16 v[28:29], v14 offset:10336
    ds_read_b64_tr_b16 v[30:31], v14 offset:12896
    ds_read_b64_tr_b16 v[32:33], v14 offset:10368
    ds_read_b64_tr_b16 v[34:35], v14 offset:12928
    v_mfma_f32_16x16x32_bf16 v[80:83], v[36:39], v[76:79], v[80:83]
    v_mfma_f32_16x16x32_bf16 v[84:87], v[40:43], v[76:79], v[84:87]
    v_mfma_f32_16x16x32_bf16 v[88:91], v[44:47], v[76:79], v[88:91]
    v_mfma_f32_16x16x32_bf16 v[92:95], v[48:51], v[76:79], v[92:95]
    v_mfma_f32_16x16x32_bf16 v[96:99], v[52:55], v[76:79], v[96:99]
    s_waitcnt lgkmcnt(0)
    ds_read_b64 v[76:77], v10 offset:3072
    ds_read_b64 v[78:79], v11 offset:3072
    ds_read_b64_tr_b16 v[36:37], v14 offset:15360
    ds_read_b64_tr_b16 v[38:39], v14 offset:17920
    ds_read_b64_tr_b16 v[40:41], v14 offset:15392
    ds_read_b64_tr_b16 v[42:43], v14 offset:17952
    ds_read_b64_tr_b16 v[44:45], v14 offset:15424
    ds_read_b64_tr_b16 v[46:47], v14 offset:17984
    ds_read_b64_tr_b16 v[48:49], v14 offset:15456
    ds_read_b64_tr_b16 v[50:51], v14 offset:18016
    ds_read_b64_tr_b16 v[52:53], v14 offset:15488
    ds_read_b64_tr_b16 v[54:55], v14 offset:18048
    v_mfma_f32_16x16x32_bf16 v[80:83], v[16:19], v[72:75], v[80:83]
    v_mfma_f32_16x16x32_bf16 v[84:87], v[20:23], v[72:75], v[84:87]
    v_mfma_f32_16x16x32_bf16 v[88:91], v[24:27], v[72:75], v[88:91]
    v_mfma_f32_16x16x32_bf16 v[92:95], v[28:31], v[72:75], v[92:95]
    v_mfma_f32_16x16x32_bf16 v[96:99], v[32:35], v[72:75], v[96:99]
    s_waitcnt lgkmcnt(0)
    s_waitcnt vmcnt(0)
    s_barrier
    ds_read_b64 v[72:73], v10 offset:4096
    ds_read_b64 v[74:75], v11 offset:4096
    ds_read_b64_tr_b16 v[16:17], v14 offset:20480
    ds_read_b64_tr_b16 v[18:19], v14 offset:23040
    ds_read_b64_tr_b16 v[20:21], v14 offset:20512
    ds_read_b64_tr_b16 v[22:23], v14 offset:23072
    ds_read_b64_tr_b16 v[24:25], v14 offset:20544
    ds_read_b64_tr_b16 v[26:27], v14 offset:23104
    ds_read_b64_tr_b16 v[28:29], v14 offset:20576
    ds_read_b64_tr_b16 v[30:31], v14 offset:23136
    ds_read_b64_tr_b16 v[32:33], v14 offset:20608
    ds_read_b64_tr_b16 v[34:35], v14 offset:23168
    v_mfma_f32_16x16x32_bf16 v[80:83], v[36:39], v[76:79], v[80:83]
    v_mfma_f32_16x16x32_bf16 v[84:87], v[40:43], v[76:79], v[84:87]
    v_mfma_f32_16x16x32_bf16 v[88:91], v[44:47], v[76:79], v[88:91]
    v_mfma_f32_16x16x32_bf16 v[92:95], v[48:51], v[76:79], v[92:95]
    v_mfma_f32_16x16x32_bf16 v[96:99], v[52:55], v[76:79], v[96:99]
    s_waitcnt lgkmcnt(0)
    buffer_load_dwordx2 v[148:149], v12, s[24:27], 0 offen offset:0
    buffer_load_dwordx2 v[150:151], v12, s[24:27], 0 offen offset:32
    buffer_load_dwordx2 v[152:153], v12, s[24:27], 0 offen offset:64
    buffer_load_dwordx2 v[154:155], v12, s[24:27], 0 offen offset:96
    buffer_load_dwordx2 v[156:157], v12, s[24:27], 0 offen offset:128
    buffer_load_dwordx2 v[158:159], v13, s[32:35], 0 offen offset:0
    buffer_load_dwordx2 v[160:161], v13, s[32:35], 0 offen offset:32
    buffer_load_dwordx2 v[162:163], v13, s[32:35], 0 offen offset:64
    buffer_load_dwordx2 v[164:165], v13, s[32:35], 0 offen offset:96
    buffer_load_dwordx2 v[166:167], v13, s[32:35], 0 offen offset:128
    ds_read_b64 v[76:77], v10 offset:5120
    ds_read_b64 v[78:79], v11 offset:5120
    ds_read_b64_tr_b16 v[36:37], v14 offset:25600
    ds_read_b64_tr_b16 v[38:39], v14 offset:28160
    ds_read_b64_tr_b16 v[40:41], v14 offset:25632
    ds_read_b64_tr_b16 v[42:43], v14 offset:28192
    ds_read_b64_tr_b16 v[44:45], v14 offset:25664
    ds_read_b64_tr_b16 v[46:47], v14 offset:28224
    ds_read_b64_tr_b16 v[48:49], v14 offset:25696
    ds_read_b64_tr_b16 v[50:51], v14 offset:28256
    ds_read_b64_tr_b16 v[52:53], v14 offset:25728
    ds_read_b64_tr_b16 v[54:55], v14 offset:28288
    v_mfma_f32_16x16x32_bf16 v[80:83], v[16:19], v[72:75], v[80:83]
    v_mfma_f32_16x16x32_bf16 v[84:87], v[20:23], v[72:75], v[84:87]
    v_mfma_f32_16x16x32_bf16 v[88:91], v[24:27], v[72:75], v[88:91]
    v_mfma_f32_16x16x32_bf16 v[92:95], v[28:31], v[72:75], v[92:95]
    v_mfma_f32_16x16x32_bf16 v[96:99], v[32:35], v[72:75], v[96:99]
    s_waitcnt lgkmcnt(0)
    ds_read_b64 v[72:73], v10 offset:6144
    ds_read_b64 v[74:75], v11 offset:6144
    ds_read_b64_tr_b16 v[16:17], v14 offset:30720
    ds_read_b64_tr_b16 v[18:19], v14 offset:33280
    ds_read_b64_tr_b16 v[20:21], v14 offset:30752
    ds_read_b64_tr_b16 v[22:23], v14 offset:33312
    ds_read_b64_tr_b16 v[24:25], v14 offset:30784
    ds_read_b64_tr_b16 v[26:27], v14 offset:33344
    ds_read_b64_tr_b16 v[28:29], v14 offset:30816
    ds_read_b64_tr_b16 v[30:31], v14 offset:33376
    ds_read_b64_tr_b16 v[32:33], v14 offset:30848
    ds_read_b64_tr_b16 v[34:35], v14 offset:33408
    v_mfma_f32_16x16x32_bf16 v[80:83], v[36:39], v[76:79], v[80:83]
    v_mfma_f32_16x16x32_bf16 v[84:87], v[40:43], v[76:79], v[84:87]
    v_mfma_f32_16x16x32_bf16 v[88:91], v[44:47], v[76:79], v[88:91]
    v_mfma_f32_16x16x32_bf16 v[92:95], v[48:51], v[76:79], v[92:95]
    v_mfma_f32_16x16x32_bf16 v[96:99], v[52:55], v[76:79], v[96:99]
    s_waitcnt lgkmcnt(0)
    ds_read_b64 v[76:77], v10 offset:7168
    ds_read_b64 v[78:79], v11 offset:7168
    ds_read_b64_tr_b16 v[36:37], v14 offset:35840
    ds_read_b64_tr_b16 v[38:39], v14 offset:38400
    ds_read_b64_tr_b16 v[40:41], v14 offset:35872
    ds_read_b64_tr_b16 v[42:43], v14 offset:38432
    ds_read_b64_tr_b16 v[44:45], v14 offset:35904
    ds_read_b64_tr_b16 v[46:47], v14 offset:38464
    ds_read_b64_tr_b16 v[48:49], v14 offset:35936
    ds_read_b64_tr_b16 v[50:51], v14 offset:38496
    ds_read_b64_tr_b16 v[52:53], v14 offset:35968
    ds_read_b64_tr_b16 v[54:55], v14 offset:38528
    v_mfma_f32_16x16x32_bf16 v[80:83], v[16:19], v[72:75], v[80:83]
    v_mfma_f32_16x16x32_bf16 v[84:87], v[20:23], v[72:75], v[84:87]
    v_mfma_f32_16x16x32_bf16 v[88:91], v[24:27], v[72:75], v[88:91]
    v_mfma_f32_16x16x32_bf16 v[92:95], v[28:31], v[72:75], v[92:95]
    v_mfma_f32_16x16x32_bf16 v[96:99], v[32:35], v[72:75], v[96:99]
    s_waitcnt lgkmcnt(0)
    v_mfma_f32_16x16x32_bf16 v[80:83], v[36:39], v[76:79], v[80:83]
    v_mfma_f32_16x16x32_bf16 v[84:87], v[40:43], v[76:79], v[84:87]
    v_mfma_f32_16x16x32_bf16 v[88:91], v[44:47], v[76:79], v[88:91]
    v_mfma_f32_16x16x32_bf16 v[92:95], v[48:51], v[76:79], v[92:95]
    v_mfma_f32_16x16x32_bf16 v[96:99], v[52:55], v[76:79], v[96:99]
    s_nop 7
    s_nop 3
    s_waitcnt vmcnt(0)
    v_mov_b32 v136, 0
    v_mov_b32 v137, 0
    v_mov_b32 v138, 0
    v_mov_b32 v139, 0
    v_add_u32 v7, 0x580000, v12
    v_cvt_pk_bf16_f32 v168, v80, v81
    v_cvt_pk_bf16_f32 v169, v82, v83
    v_lshlrev_b32 v170, 16, v168
    v_and_b32 v171, 0xffff0000, v168
    v_lshlrev_b32 v174, 16, v148
    v_and_b32 v175, 0xffff0000, v148
    v_lshlrev_b32 v172, 16, v169
    v_and_b32 v173, 0xffff0000, v169
    v_lshlrev_b32 v176, 16, v149
    v_and_b32 v177, 0xffff0000, v149
    v_add_f32 v170, v170, v174
    v_add_f32 v171, v171, v175
    v_add_f32 v172, v172, v176
    v_add_f32 v173, v173, v177
    v_cvt_pk_bf16_f32 v178, v170, v171
    v_cvt_pk_bf16_f32 v179, v172, v173
    buffer_store_dwordx2 v[178:179], v7, s[28:31], 0 offen offset:0
    v_dot2c_f32_bf16 v136, v178, v144
    v_dot2c_f32_bf16 v137, v178, v178
    v_dot2c_f32_bf16 v138, v178, v158
    v_dot2c_f32_bf16 v136, v179, v144
    v_dot2c_f32_bf16 v137, v179, v179
    v_dot2c_f32_bf16 v138, v179, v159
    v_cvt_pk_bf16_f32 v184, v84, v85
    v_cvt_pk_bf16_f32 v185, v86, v87
    v_lshlrev_b32 v186, 16, v184
    v_and_b32 v187, 0xffff0000, v184
    v_lshlrev_b32 v190, 16, v150
    v_and_b32 v191, 0xffff0000, v150
    v_lshlrev_b32 v188, 16, v185
    v_and_b32 v189, 0xffff0000, v185
    v_lshlrev_b32 v192, 16, v151
    v_and_b32 v193, 0xffff0000, v151
    v_add_f32 v186, v186, v190
    v_add_f32 v187, v187, v191
    v_add_f32 v188, v188, v192
    v_add_f32 v189, v189, v193
    v_cvt_pk_bf16_f32 v194, v186, v187
    v_cvt_pk_bf16_f32 v195, v188, v189
    buffer_store_dwordx2 v[194:195], v7, s[28:31], 0 offen offset:32
    v_dot2c_f32_bf16 v136, v194, v144
    v_dot2c_f32_bf16 v137, v194, v194
    v_dot2c_f32_bf16 v138, v194, v160
    v_dot2c_f32_bf16 v136, v195, v144
    v_dot2c_f32_bf16 v137, v195, v195
    v_dot2c_f32_bf16 v138, v195, v161
    v_cvt_pk_bf16_f32 v200, v88, v89
    v_cvt_pk_bf16_f32 v201, v90, v91
    v_lshlrev_b32 v202, 16, v200
    v_and_b32 v203, 0xffff0000, v200
    v_lshlrev_b32 v206, 16, v152
    v_and_b32 v207, 0xffff0000, v152
    v_lshlrev_b32 v204, 16, v201
    v_and_b32 v205, 0xffff0000, v201
    v_lshlrev_b32 v208, 16, v153
    v_and_b32 v209, 0xffff0000, v153
    v_add_f32 v202, v202, v206
    v_add_f32 v203, v203, v207
    v_add_f32 v204, v204, v208
    v_add_f32 v205, v205, v209
    v_cvt_pk_bf16_f32 v210, v202, v203
    v_cvt_pk_bf16_f32 v211, v204, v205
    buffer_store_dwordx2 v[210:211], v7, s[28:31], 0 offen offset:64
    v_dot2c_f32_bf16 v136, v210, v144
    v_dot2c_f32_bf16 v137, v210, v210
    v_dot2c_f32_bf16 v138, v210, v162
    v_dot2c_f32_bf16 v136, v211, v144
    v_dot2c_f32_bf16 v137, v211, v211
    v_dot2c_f32_bf16 v138, v211, v163
    v_cvt_pk_bf16_f32 v216, v92, v93
    v_cvt_pk_bf16_f32 v217, v94, v95
    v_lshlrev_b32 v218, 16, v216
    v_and_b32 v219, 0xffff0000, v216
    v_lshlrev_b32 v222, 16, v154
    v_and_b32 v223, 0xffff0000, v154
    v_lshlrev_b32 v220, 16, v217
    v_and_b32 v221, 0xffff0000, v217
    v_lshlrev_b32 v224, 16, v155
    v_and_b32 v225, 0xffff0000, v155
    v_add_f32 v218, v218, v222
    v_add_f32 v219, v219, v223
    v_add_f32 v220, v220, v224
    v_add_f32 v221, v221, v225
    v_cvt_pk_bf16_f32 v226, v218, v219
    v_cvt_pk_bf16_f32 v227, v220, v221
    buffer_store_dwordx2 v[226:227], v7, s[28:31], 0 offen offset:96
    v_dot2c_f32_bf16 v136, v226, v144
    v_dot2c_f32_bf16 v137, v226, v226
    v_dot2c_f32_bf16 v138, v226, v164
    v_dot2c_f32_bf16 v136, v227, v144
    v_dot2c_f32_bf16 v137, v227, v227
    v_dot2c_f32_bf16 v138, v227, v165
    v_cvt_pk_bf16_f32 v232, v96, v97
    v_cvt_pk_bf16_f32 v233, v98, v99
    v_lshlrev_b32 v234, 16, v232
    v_and_b32 v235, 0xffff0000, v232
    v_lshlrev_b32 v238, 16, v156
    v_and_b32 v239, 0xffff0000, v156
    v_lshlrev_b32 v236, 16, v233
    v_and_b32 v237, 0xffff0000, v233
    v_lshlrev_b32 v240, 16, v157
    v_and_b32 v241, 0xffff0000, v157
    v_add_f32 v234, v234, v238
    v_add_f32 v235, v235, v239
    v_add_f32 v236, v236, v240
    v_add_f32 v237, v237, v241
    v_cvt_pk_bf16_f32 v242, v234, v235
    v_cvt_pk_bf16_f32 v243, v236, v237
    buffer_store_dwordx2 v[242:243], v7, s[28:31], 0 offen offset:128
    v_dot2c_f32_bf16 v136, v242, v144
    v_dot2c_f32_bf16 v137, v242, v242
    v_dot2c_f32_bf16 v138, v242, v166
    v_dot2c_f32_bf16 v136, v243, v144
    v_dot2c_f32_bf16 v137, v243, v243
    v_dot2c_f32_bf16 v138, v243, v167
    s_nop 3
    v_mov_b32 v16, v136
    v_mov_b32 v17, v136
    s_nop 1
    v_permlane32_swap_b32 v16, v17
    s_nop 1
    v_add_f32 v136, v16, v17
    v_mov_b32 v16, v136
    v_mov_b32 v17, v136
    s_nop 1
    v_permlane16_swap_b32 v16, v17
    s_nop 1
    v_add_f32 v136, v16, v17
    v_mov_b32 v16, v137
    v_mov_b32 v17, v137
    s_nop 1
    v_permlane32_swap_b32 v16, v17
    s_nop 1
    v_add_f32 v137, v16, v17
    v_mov_b32 v16, v137
    v_mov_b32 v17, v137
    s_nop 1
    v_permlane16_swap_b32 v16, v17
    s_nop 1
    v_add_f32 v137, v16, v17
    v_mov_b32 v16, v138
    v_mov_b32 v17, v138
    s_nop 1
    v_permlane32_swap_b32 v16, v17
    s_nop 1
    v_add_f32 v138, v16, v17
    v_mov_b32 v16, v138
    v_mov_b32 v17, v138
    s_nop 1
    v_permlane16_swap_b32 v16, v17
    s_nop 1
    v_add_f32 v138, v16, v17
    v_cmp_eq_u32 vcc, 1, v3
    s_nop 1
    v_cndmask_b32 v136, v136, v137, vcc
    v_cmp_eq_u32 vcc, 2, v3
    s_nop 1
    v_cndmask_b32 v136, v136, v138, vcc
    v_cmp_eq_u32 vcc, 3, v3
    s_nop 1
    v_cndmask_b32 v136, v136, v139, vcc
    v_lshlrev_b32 v8, 4, v6
    v_lshl_add_u32 v8, v3, 2, v8
    v_add_u32 v8, 0x2a9000, v8
    buffer_atomic_add_f32 v136, v8, s[28:31], 0 offen
k3_kernel_end:
k3_kernel_exit:
    s_endpgm
.section .rodata,"a"
.p2align 6
.amdhsa_kernel k3_kernel
  .amdhsa_next_free_vgpr 256
  .amdhsa_next_free_sgpr 56
  .amdhsa_accum_offset 256
  .amdhsa_group_segment_fixed_size 0
  .amdhsa_kernarg_size 104
  .amdhsa_user_sgpr_count 2
  .amdhsa_user_sgpr_kernarg_segment_ptr 1
  .amdhsa_system_sgpr_workgroup_id_x 1
.end_amdhsa_kernel

.text
.globl k4_kernel
.p2align 8
.type k4_kernel,@function
k4_kernel:
    s_cmp_ge_u32 s2, 182
    s_cbranch_scc1 k4_kernel_exit
    s_load_dwordx2 s[4:5], s[0:1], 96
    s_load_dwordx4 s[20:23], s[0:1], 80
    s_load_dwordx4 s[24:27], s[0:1], 48
    s_load_dwordx4 s[28:31], s[0:1], 64
    v_and_b32 v1, 63, v0
    v_lshrrev_b32 v2, 6, v0
    v_lshlrev_b32 v3, 6, v0
    v_readfirstlane_b32 s3, v2
    v_add_u32 v3, 0x2a9000, v3
    v_mov_b32 v4, 0x810000
    s_waitcnt lgkmcnt(0)
    s_mov_b32 s8, s4
    s_and_b32 s9, s5, 0xffff
    s_mov_b32 s10, 0x1400000
    s_mov_b32 s11, 0x00020000
    buffer_load_dwordx4 v[16:19], v3, s[8:11], 0 offen offset:0
    buffer_load_dwordx4 v[20:23], v3, s[8:11], 0 offen offset:16
    buffer_load_dwordx4 v[24:27], v3, s[8:11], 0 offen offset:32
    buffer_load_dwordx4 v[28:31], v3, s[8:11], 0 offen offset:48
    buffer_load_dword v11, v4, s[8:11], 0 offen
    s_mov_b32 s12, s20
    s_and_b32 s13, s21, 0xffff
    s_mov_b32 s14, 0x280000
    s_mov_b32 s15, 0x00020000
    s_cmp_ge_u32 s2, 54
    s_cbranch_scc1 k4_kernel_rowsld
    s_mov_b32 s44, s26
    s_and_b32 s45, s27, 0xffff
    s_mov_b32 s46, 0x21c000
    s_mov_b32 s47, 0x00020000
    s_mov_b32 s48, s28
    s_and_b32 s49, s29, 0xffff
    s_mov_b32 s50, 0x21c000
    s_mov_b32 s51, 0x00020000
    s_mov_b32 s52, s30
    s_and_b32 s53, s31, 0xffff
    s_mov_b32 s54, 0x21c000
    s_mov_b32 s55, 0x00020000
    s_mov_b32 s56, s22
    s_and_b32 s57, s23, 0xffff
    s_mov_b32 s58, 0x100
    s_mov_b32 s59, 0x00020000
    s_waitcnt vmcnt(0)
    s_branch k4_kernel_lddone
k4_kernel_rowsld:
    v_lshrrev_b32 v4, 5, v0
    s_sub_u32 s34, s2, 54
    s_lshl_b32 s34, s34, 4
    v_add_u32 v4, s34, v4
    v_and_b32 v5, 31, v0
    v_mul_u32_u24 v6, 1280, v4
    v_lshl_add_u32 v6, v5, 4, v6
    v_add_u32 v7, 0x580000, v6
    buffer_load_dwordx4 v[40:43], v7, s[8:11], 0 offen offset:0
    buffer_load_dwordx4 v[44:47], v7, s[8:11], 0 offen offset:512
    buffer_load_dwordx4 v[48:51], v7, s[8:11], 0 offen offset:1024
    v_lshlrev_b32 v7, 4, v4
    v_add_u32 v7, 0x2a9000, v7
    buffer_load_dwordx4 v[52:55], v7, s[8:11], 0 offen
    s_waitcnt vmcnt(4)
k4_kernel_lddone:
    v_lshlrev_b32 v14, 2, v0
    v_sub_u32 v14, 2047, v14
    s_mov_b32 s40, 0xfffff800
    v_mul_f32 v104, 0x3acccccd, v16
    v_mul_f32 v105, 0x3acccccd, v17
    v_fma_f32 v105, -v104, v104, v105
    v_max_f32 v105, 0, v105
    v_add_f32 v105, 0x3727c5ac, v105
    v_rsq_f32 v105, v105
    v_fma_f32 v106, -v104, v11, v18
    v_mul_f32 v106, v106, v105
    v_ashrrev_i32 v107, 31, v106
    v_or_b32 v107, 0x80000000, v107
    v_xor_b32 v106, v106, v107
    v_subrev_u32 v107, 0, v14
    v_and_or_b32 v106, v106, s40, v107
    v_mov_b32 v13, v106
    v_mul_f32 v104, 0x3acccccd, v20
    v_mul_f32 v105, 0x3acccccd, v21
    v_fma_f32 v105, -v104, v104, v105
    v_max_f32 v105, 0, v105
    v_add_f32 v105, 0x3727c5ac, v105
    v_rsq_f32 v105, v105
    v_fma_f32 v106, -v104, v11, v22
    v_mul_f32 v106, v106, v105
    v_ashrrev_i32 v107, 31, v106
    v_or_b32 v107, 0x80000000, v107
    v_xor_b32 v106, v106, v107
    v_subrev_u32 v107, 1, v14
    v_and_or_b32 v106, v106, s40, v107
    v_max_u32 v13, v13, v106
    v_mul_f32 v104, 0x3acccccd, v24
    v_mul_f32 v105, 0x3acccccd, v25
    v_fma_f32 v105, -v104, v104, v105
    v_max_f32 v105, 0, v105
    v_add_f32 v105, 0x3727c5ac, v105
    v_rsq_f32 v105, v105
    v_fma_f32 v106, -v104, v11, v26
    v_mul_f32 v106, v106, v105
    v_ashrrev_i32 v107, 31, v106
    v_or_b32 v107, 0x80000000, v107
    v_xor_b32 v106, v106, v107
    v_subrev_u32 v107, 2, v14
    v_and_or_b32 v106, v106, s40, v107
    v_max_u32 v13, v13, v106
    v_mul_f32 v104, 0x3acccccd, v28
    v_mul_f32 v105, 0x3acccccd, v29
    v_fma_f32 v105, -v104, v104, v105
    v_max_f32 v105, 0, v105
    v_add_f32 v105, 0x3727c5ac, v105
    v_rsq_f32 v105, v105
    v_fma_f32 v106, -v104, v11, v30
    v_mul_f32 v106, v106, v105
    v_ashrrev_i32 v107, 31, v106
    v_or_b32 v107, 0x80000000, v107
    v_xor_b32 v106, v106, v107
    v_subrev_u32 v107, 3, v14
    v_and_or_b32 v106, v106, s40, v107
    v_max_u32 v13, v13, v106
    s_nop 1
    v_max_u32_dpp v13, v13, v13 row_ror:8 row_mask:0xf bank_mask:0xf
    s_nop 1
    v_max_u32_dpp v13, v13, v13 row_ror:4 row_mask:0xf bank_mask:0xf
    s_nop 1
    v_max_u32_dpp v13, v13, v13 row_ror:2 row_mask:0xf bank_mask:0xf
    s_nop 1
    v_max_u32_dpp v13, v13, v13 row_ror:1 row_mask:0xf bank_mask:0xf
    v_mov_b32 v104, v13
    v_mov_b32 v105, v13
    s_nop 1
    v_permlane16_swap_b32 v104, v105
    s_nop 1
    v_max_u32 v13, v104, v105
    v_mov_b32 v104, v13
    v_mov_b32 v105, v13
    s_nop 1
    v_permlane32_swap_b32 v104, v105
    s_nop 1
    v_max_u32 v13, v104, v105
    s_lshl_b32 s35, s3, 2
    v_mov_b32 v104, s35
    ds_write_b32 v104, v13
    s_waitcnt lgkmcnt(0)
    s_barrier
    v_mov_b32 v104, 0
    ds_read_b128 v[108:111], v104
    ds_read_b128 v[112:115], v104 offset:16
    s_waitcnt lgkmcnt(0)
    v_max3_u32 v13, v108, v109, v110
    v_max3_u32 v13, v13, v111, v112
    v_max3_u32 v13, v13, v113, v114
    v_max_u32 v13, v13, v115
    v_and_b32 v13, 0x7ff, v13
    v_sub_u32 v13, 2047, v13
    s_nop 0
    v_readfirstlane_b32 s36, v13
    s_cmp_lt_u32 s2, 54
    s_cbranch_scc1 k4_kernel_ffn
    s_waitcnt vmcnt(0)
    v_mul_f32 v56, 0x3acccccd, v52
    v_mul_f32 v58, 0x3acccccd, v53
    v_fma_f32 v58, -v56, v56, v58
    v_max_f32 v58, 0, v58
    v_cvt_pk_bf16_f32 v56, v56, v56
    v_lshlrev_b32 v56, 16, v56
    v_cvt_pk_bf16_f32 v58, v58, v58
    v_lshlrev_b32 v58, 16, v58
    v_add_f32 v58, 0x3727c5ac, v58
    v_cvt_pk_bf16_f32 v58, v58, v58
    v_lshlrev_b32 v58, 16, v58
    v_sqrt_f32 v58, v58
    s_nop 0
    v_cvt_pk_bf16_f32 v58, v58, v58
    v_lshlrev_b32 v58, 16, v58
    v_rcp_f32 v57, v58
    s_nop 0
    v_cmp_ne_u32 s[38:39], s36, v4
    v_lshlrev_b32 v60, 16, v40
    v_and_b32 v61, 0xffff0000, v40
    v_lshlrev_b32 v62, 16, v41
    v_and_b32 v63, 0xffff0000, v41
    v_lshlrev_b32 v64, 16, v42
    v_and_b32 v65, 0xffff0000, v42
    v_lshlrev_b32 v66, 16, v43
    v_and_b32 v67, 0xffff0000, v43
    v_sub_f32 v68, v60, v56
    v_sub_f32 v69, v61, v56
    v_sub_f32 v70, v62, v56
    v_sub_f32 v71, v63, v56
    v_sub_f32 v72, v64, v56
    v_sub_f32 v73, v65, v56
    v_sub_f32 v74, v66, v56
    v_sub_f32 v75, v67, v56
    v_cvt_pk_bf16_f32 v76, v68, v69
    v_cvt_pk_bf16_f32 v77, v70, v71
    v_cvt_pk_bf16_f32 v78, v72, v73
    v_cvt_pk_bf16_f32 v79, v74, v75
    v_lshlrev_b32 v68, 16, v76
    v_and_b32 v69, 0xffff0000, v76
    v_lshlrev_b32 v70, 16, v77
    v_and_b32 v71, 0xffff0000, v77
    v_lshlrev_b32 v72, 16, v78
    v_and_b32 v73, 0xffff0000, v78
    v_lshlrev_b32 v74, 16, v79
    v_and_b32 v75, 0xffff0000, v79
    v_mul_f32 v68, v57, v68
    v_mul_f32 v69, v57, v69
    v_mul_f32 v70, v57, v70
    v_mul_f32 v71, v57, v71
    v_mul_f32 v72, v57, v72
    v_mul_f32 v73, v57, v73
    v_mul_f32 v74, v57, v74
    v_mul_f32 v75, v57, v75
    v_cvt_pk_bf16_f32 v76, v68, v69
    v_cvt_pk_bf16_f32 v77, v70, v71
    v_cvt_pk_bf16_f32 v78, v72, v73
    v_cvt_pk_bf16_f32 v79, v74, v75
    v_lshlrev_b32 v68, 16, v76
    v_and_b32 v69, 0xffff0000, v76
    v_lshlrev_b32 v70, 16, v77
    v_and_b32 v71, 0xffff0000, v77
    v_lshlrev_b32 v72, 16, v78
    v_and_b32 v73, 0xffff0000, v78
    v_lshlrev_b32 v74, 16, v79
    v_and_b32 v75, 0xffff0000, v79
    v_add_f32 v68, v60, v68
    v_add_f32 v69, v61, v69
    v_add_f32 v70, v62, v70
    v_add_f32 v71, v63, v71
    v_add_f32 v72, v64, v72
    v_add_f32 v73, v65, v73
    v_add_f32 v74, v66, v74
    v_add_f32 v75, v67, v75
    v_cvt_pk_bf16_f32 v80, v68, v69
    v_cvt_pk_bf16_f32 v81, v70, v71
    v_cvt_pk_bf16_f32 v82, v72, v73
    v_cvt_pk_bf16_f32 v83, v74, v75
    v_lshlrev_b32 v60, 16, v44
    v_and_b32 v61, 0xffff0000, v44
    v_lshlrev_b32 v62, 16, v45
    v_and_b32 v63, 0xffff0000, v45
    v_lshlrev_b32 v64, 16, v46
    v_and_b32 v65, 0xffff0000, v46
    v_lshlrev_b32 v66, 16, v47
    v_and_b32 v67, 0xffff0000, v47
    v_sub_f32 v68, v60, v56
    v_sub_f32 v69, v61, v56
    v_sub_f32 v70, v62, v56
    v_sub_f32 v71, v63, v56
    v_sub_f32 v72, v64, v56
    v_sub_f32 v73, v65, v56
    v_sub_f32 v74, v66, v56
    v_sub_f32 v75, v67, v56
    v_cvt_pk_bf16_f32 v76, v68, v69
    v_cvt_pk_bf16_f32 v77, v70, v71
    v_cvt_pk_bf16_f32 v78, v72, v73
    v_cvt_pk_bf16_f32 v79, v74, v75
    v_lshlrev_b32 v68, 16, v76
    v_and_b32 v69, 0xffff0000, v76
    v_lshlrev_b32 v70, 16, v77
    v_and_b32 v71, 0xffff0000, v77
    v_lshlrev_b32 v72, 16, v78
    v_and_b32 v73, 0xffff0000, v78
    v_lshlrev_b32 v74, 16, v79
    v_and_b32 v75, 0xffff0000, v79
    v_mul_f32 v68, v57, v68
    v_mul_f32 v69, v57, v69
    v_mul_f32 v70, v57, v70
    v_mul_f32 v71, v57, v71
    v_mul_f32 v72, v57, v72
    v_mul_f32 v73, v57, v73
    v_mul_f32 v74, v57, v74
    v_mul_f32 v75, v57, v75
    v_cvt_pk_bf16_f32 v76, v68, v69
    v_cvt_pk_bf16_f32 v77, v70, v71
    v_cvt_pk_bf16_f32 v78, v72, v73
    v_cvt_pk_bf16_f32 v79, v74, v75
    v_lshlrev_b32 v68, 16, v76
    v_and_b32 v69, 0xffff0000, v76
    v_lshlrev_b32 v70, 16, v77
    v_and_b32 v71, 0xffff0000, v77
    v_lshlrev_b32 v72, 16, v78
    v_and_b32 v73, 0xffff0000, v78
    v_lshlrev_b32 v74, 16, v79
    v_and_b32 v75, 0xffff0000, v79
    v_add_f32 v68, v60, v68
    v_add_f32 v69, v61, v69
    v_add_f32 v70, v62, v70
    v_add_f32 v71, v63, v71
    v_add_f32 v72, v64, v72
    v_add_f32 v73, v65, v73
    v_add_f32 v74, v66, v74
    v_add_f32 v75, v67, v75
    v_cvt_pk_bf16_f32 v84, v68, v69
    v_cvt_pk_bf16_f32 v85, v70, v71
    v_cvt_pk_bf16_f32 v86, v72, v73
    v_cvt_pk_bf16_f32 v87, v74, v75
    v_lshlrev_b32 v60, 16, v48
    v_and_b32 v61, 0xffff0000, v48
    v_lshlrev_b32 v62, 16, v49
    v_and_b32 v63, 0xffff0000, v49
    v_lshlrev_b32 v64, 16, v50
    v_and_b32 v65, 0xffff0000, v50
    v_lshlrev_b32 v66, 16, v51
    v_and_b32 v67, 0xffff0000, v51
    v_sub_f32 v68, v60, v56
    v_sub_f32 v69, v61, v56
    v_sub_f32 v70, v62, v56
    v_sub_f32 v71, v63, v56
    v_sub_f32 v72, v64, v56
    v_sub_f32 v73, v65, v56
    v_sub_f32 v74, v66, v56
    v_sub_f32 v75, v67, v56
    v_cvt_pk_bf16_f32 v76, v68, v69
    v_cvt_pk_bf16_f32 v77, v70, v71
    v_cvt_pk_bf16_f32 v78, v72, v73
    v_cvt_pk_bf16_f32 v79, v74, v75
    v_lshlrev_b32 v68, 16, v76
    v_and_b32 v69, 0xffff0000, v76
    v_lshlrev_b32 v70, 16, v77
    v_and_b32 v71, 0xffff0000, v77
    v_lshlrev_b32 v72, 16, v78
    v_and_b32 v73, 0xffff0000, v78
    v_lshlrev_b32 v74, 16, v79
    v_and_b32 v75, 0xffff0000, v79
    v_mul_f32 v68, v57, v68
    v_mul_f32 v69, v57, v69
    v_mul_f32 v70, v57, v70
    v_mul_f32 v71, v57, v71
    v_mul_f32 v72, v57, v72
    v_mul_f32 v73, v57, v73
    v_mul_f32 v74, v57, v74
    v_mul_f32 v75, v57, v75
    v_cvt_pk_bf16_f32 v76, v68, v69
    v_cvt_pk_bf16_f32 v77, v70, v71
    v_cvt_pk_bf16_f32 v78, v72, v73
    v_cvt_pk_bf16_f32 v79, v74, v75
    v_lshlrev_b32 v68, 16, v76
    v_and_b32 v69, 0xffff0000, v76
    v_lshlrev_b32 v70, 16, v77
    v_and_b32 v71, 0xffff0000, v77
    v_lshlrev_b32 v72, 16, v78
    v_and_b32 v73, 0xffff0000, v78
    v_lshlrev_b32 v74, 16, v79
    v_and_b32 v75, 0xffff0000, v79
    v_add_f32 v68, v60, v68
    v_add_f32 v69, v61, v69
    v_add_f32 v70, v62, v70
    v_add_f32 v71, v63, v71
    v_add_f32 v72, v64, v72
    v_add_f32 v73, v65, v73
    v_add_f32 v74, v66, v74
    v_add_f32 v75, v67, v75
    v_cvt_pk_bf16_f32 v88, v68, v69
    v_cvt_pk_bf16_f32 v89, v70, v71
    v_cvt_pk_bf16_f32 v90, v72, v73
    v_cvt_pk_bf16_f32 v91, v74, v75
    v_cmp_gt_u32 vcc, 16, v5
    s_nop 3
    s_and_b64 vcc, vcc, s[38:39]
    s_mov_b64 exec, s[38:39]
    s_cbranch_execz k4_kernel_sk_1
    buffer_store_dwordx4 v[80:83], v6, s[12:15], 0 offen
    buffer_store_dwordx4 v[84:87], v6, s[12:15], 0 offen offset:512
    s_mov_b64 exec, vcc
    buffer_store_dwordx4 v[88:91], v6, s[12:15], 0 offen offset:1024
k4_kernel_sk_1:
    s_mov_b64 exec, -1
    s_branch k4_kernel_end
k4_kernel_ffn:
    v_lshrrev_b32 v8, 2, v0
    s_mul_i32 s37, s36, 1280
    s_add_u32 s35, s37, 0x580000
    v_lshlrev_b32 v104, 1, v8
    v_add_u32 v104, s35, v104
    buffer_load_ushort v16, v104, s[8:11], 0 offen offset:0
    buffer_load_ushort v17, v104, s[8:11], 0 offen offset:256
    buffer_load_ushort v18, v104, s[8:11], 0 offen offset:512
    buffer_load_ushort v19, v104, s[8:11], 0 offen offset:768
    buffer_load_ushort v20, v104, s[8:11], 0 offen offset:1024
    s_lshl_b32 s35, s36, 4
    s_add_u32 s35, s35, 0x2a9000
    v_mov_b32 v105, s35
    buffer_load_dwordx4 v[24:27], v105, s[8:11], 0 offen
    v_lshrrev_b32 v8, 2, v0
    v_and_b32 v9, 3, v0
    v_mul_u32_u24 v10, 3456, v8
    v_lshl_add_u32 v10, v9, 4, v10
    s_lshl_b32 s35, s2, 6
    v_add_u32 v10, s35, v10
    s_mov_b32 s35, 0
    buffer_load_dwordx4 v[40:43], v10, s[44:47], s35 offen
    buffer_load_dwordx4 v[60:63], v10, s[48:51], s35 offen
    s_mov_b32 s35, 442368
    buffer_load_dwordx4 v[44:47], v10, s[44:47], s35 offen
    buffer_load_dwordx4 v[64:67], v10, s[48:51], s35 offen
    s_mov_b32 s35, 884736
    buffer_load_dwordx4 v[48:51], v10, s[44:47], s35 offen
    buffer_load_dwordx4 v[68:71], v10, s[48:51], s35 offen
    s_mov_b32 s35, 1327104
    buffer_load_dwordx4 v[52:55], v10, s[44:47], s35 offen
    buffer_load_dwordx4 v[72:75], v10, s[48:51], s35 offen
    s_mov_b32 s35, 1769472
    buffer_load_dwordx4 v[56:59], v10, s[44:47], s35 offen
    buffer_load_dwordx4 v[76:79], v10, s[48:51], s35 offen
    v_min_u32 v4, 479, v0
    v_mul_u32_u24 v5, 0x334, v4
    v_lshrrev_b32 v5, 16, v5
    v_mul_u32_u24 v6, 80, v5
    v_sub_u32 v6, v4, v6
    s_lshl_b32 s35, s2, 5
    v_add_u32 v7, s35, v5
    v_mul_u32_u24 v7, 1280, v7
    v_lshl_add_u32 v7, v6, 4, v7
    s_mov_b32 s35, 0
    buffer_load_dwordx4 v[80:83], v7, s[52:55], s35 offen
    s_mov_b32 s35, 7680
    buffer_load_dwordx4 v[84:87], v7, s[52:55], s35 offen
    s_mov_b32 s35, 15360
    buffer_load_dwordx4 v[88:91], v7, s[52:55], s35 offen
    s_mov_b32 s35, 23040
    buffer_load_dwordx4 v[92:95], v7, s[52:55], s35 offen
    s_mov_b32 s35, 30720
    buffer_load_dwordx4 v[96:99], v7, s[52:55], s35 offen
    s_mov_b32 s35, 38400
    buffer_load_dwordx4 v[100:103], v7, s[52:55], s35 offen
    v_mov_b32 v112, 0
    v_mov_b32 v113, 0
    v_mov_b32 v114, 0
    v_mov_b32 v115, 0
    v_mov_b32 v116, 0
    v_mov_b32 v117, 0
    v_mov_b32 v118, 0
    v_mov_b32 v119, 0
    v_mov_b32 v120, 0
    v_mov_b32 v121, 0
    v_mov_b32 v122, 0
    v_mov_b32 v123, 0
    v_mov_b32 v124, 0
    v_mov_b32 v125, 0
    v_mov_b32 v126, 0
    v_mov_b32 v127, 0
    s_waitcnt vmcnt(16)
    v_mul_f32 v28, 0x3acccccd, v24
    v_mul_f32 v106, 0x3acccccd, v25
    v_fma_f32 v106, -v28, v28, v106
    v_max_f32 v106, 0, v106
    v_cvt_pk_bf16_f32 v28, v28, v28
    v_lshlrev_b32 v28, 16, v28
    v_cvt_pk_bf16_f32 v106, v106, v106
    v_lshlrev_b32 v106, 16, v106
    v_add_f32 v106, 0x3727c5ac, v106
    v_cvt_pk_bf16_f32 v106, v106, v106
    v_lshlrev_b32 v106, 16, v106
    v_sqrt_f32 v106, v106
    s_nop 0
    v_cvt_pk_bf16_f32 v106, v106, v106
    v_lshlrev_b32 v106, 16, v106
    v_rcp_f32 v29, v106
    s_nop 0
    v_fma_f32 v13, -v28, v11, v26
    v_mul_f32 v13, v13, v29
    v_lshlrev_b32 v16, 16, v16
    v_sub_f32 v16, v16, v28
    v_cvt_pk_bf16_f32 v16, v16, v16
    v_lshlrev_b32 v16, 16, v16
    v_mul_f32 v16, v29, v16
    v_cvt_pk_bf16_f32 v16, v16, v16
    v_lshlrev_b32 v16, 16, v16
    s_waitcnt vmcnt(14)
    v_lshlrev_b32 v104, 16, v40
    v_and_b32 v105, 0xffff0000, v40
    v_lshlrev_b32 v106, 16, v41
    v_and_b32 v107, 0xffff0000, v41
    v_lshlrev_b32 v108, 16, v42
    v_and_b32 v109, 0xffff0000, v42
    v_lshlrev_b32 v110, 16, v43
    v_and_b32 v111, 0xffff0000, v43
    v_fmac_f32 v112, v16, v104
    v_fmac_f32 v113, v16, v105
    v_fmac_f32 v114, v16, v106
    v_fmac_f32 v115, v16, v107
    v_fmac_f32 v116, v16, v108
    v_fmac_f32 v117, v16, v109
    v_fmac_f32 v118, v16, v110
    v_fmac_f32 v119, v16, v111
    v_lshlrev_b32 v104, 16, v60
    v_and_b32 v105, 0xffff0000, v60
    v_lshlrev_b32 v106, 16, v61
    v_and_b32 v107, 0xffff0000, v61
    v_lshlrev_b32 v108, 16, v62
    v_and_b32 v109, 0xffff0000, v62
    v_lshlrev_b32 v110, 16, v63
    v_and_b32 v111, 0xffff0000, v63
    v_fmac_f32 v120, v16, v104
    v_fmac_f32 v121, v16, v105
    v_fmac_f32 v122, v16, v106
    v_fmac_f32 v123, v16, v107
    v_fmac_f32 v124, v16, v108
    v_fmac_f32 v125, v16, v109
    v_fmac_f32 v126, v16, v110
    v_fmac_f32 v127, v16, v111
    v_lshlrev_b32 v17, 16, v17
    v_sub_f32 v17, v17, v28
    v_cvt_pk_bf16_f32 v17, v17, v17
    v_lshlrev_b32 v17, 16, v17
    v_mul_f32 v17, v29, v17
    v_cvt_pk_bf16_f32 v17, v17, v17
    v_lshlrev_b32 v17, 16, v17
    s_waitcnt vmcnt(12)
    v_lshlrev_b32 v104, 16, v44
    v_and_b32 v105, 0xffff0000, v44
    v_lshlrev_b32 v106, 16, v45
    v_and_b32 v107, 0xffff0000, v45
    v_lshlrev_b32 v108, 16, v46
    v_and_b32 v109, 0xffff0000, v46
    v_lshlrev_b32 v110, 16, v47
    v_and_b32 v111, 0xffff0000, v47
    v_fmac_f32 v112, v17, v104
    v_fmac_f32 v113, v17, v105
    v_fmac_f32 v114, v17, v106
    v_fmac_f32 v115, v17, v107
    v_fmac_f32 v116, v17, v108
    v_fmac_f32 v117, v17, v109
    v_fmac_f32 v118, v17, v110
    v_fmac_f32 v119, v17, v111
    v_lshlrev_b32 v104, 16, v64
    v_and_b32 v105, 0xffff0000, v64
    v_lshlrev_b32 v106, 16, v65
    v_and_b32 v107, 0xffff0000, v65
    v_lshlrev_b32 v108, 16, v66
    v_and_b32 v109, 0xffff0000, v66
    v_lshlrev_b32 v110, 16, v67
    v_and_b32 v111, 0xffff0000, v67
    v_fmac_f32 v120, v17, v104
    v_fmac_f32 v121, v17, v105
    v_fmac_f32 v122, v17, v106
    v_fmac_f32 v123, v17, v107
    v_fmac_f32 v124, v17, v108
    v_fmac_f32 v125, v17, v109
    v_fmac_f32 v126, v17, v110
    v_fmac_f32 v127, v17, v111
    v_lshlrev_b32 v18, 16, v18
    v_sub_f32 v18, v18, v28
    v_cvt_pk_bf16_f32 v18, v18, v18
    v_lshlrev_b32 v18, 16, v18
    v_mul_f32 v18, v29, v18
    v_cvt_pk_bf16_f32 v18, v18, v18
    v_lshlrev_b32 v18, 16, v18
    s_waitcnt vmcnt(10)
    v_lshlrev_b32 v104, 16, v48
    v_and_b32 v105, 0xffff0000, v48
    v_lshlrev_b32 v106, 16, v49
    v_and_b32 v107, 0xffff0000, v49
    v_lshlrev_b32 v108, 16, v50
    v_and_b32 v109, 0xffff0000, v50
    v_lshlrev_b32 v110, 16, v51
    v_and_b32 v111, 0xffff0000, v51
    v_fmac_f32 v112, v18, v104
    v_fmac_f32 v113, v18, v105
    v_fmac_f32 v114, v18, v106
    v_fmac_f32 v115, v18, v107
    v_fmac_f32 v116, v18, v108
    v_fmac_f32 v117, v18, v109
    v_fmac_f32 v118, v18, v110
    v_fmac_f32 v119, v18, v111
    v_lshlrev_b32 v104, 16, v68
    v_and_b32 v105, 0xffff0000, v68
    v_lshlrev_b32 v106, 16, v69
    v_and_b32 v107, 0xffff0000, v69
    v_lshlrev_b32 v108, 16, v70
    v_and_b32 v109, 0xffff0000, v70
    v_lshlrev_b32 v110, 16, v71
    v_and_b32 v111, 0xffff0000, v71
    v_fmac_f32 v120, v18, v104
    v_fmac_f32 v121, v18, v105
    v_fmac_f32 v122, v18, v106
    v_fmac_f32 v123, v18, v107
    v_fmac_f32 v124, v18, v108
    v_fmac_f32 v125, v18, v109
    v_fmac_f32 v126, v18, v110
    v_fmac_f32 v127, v18, v111
    v_lshlrev_b32 v19, 16, v19
    v_sub_f32 v19, v19, v28
    v_cvt_pk_bf16_f32 v19, v19, v19
    v_lshlrev_b32 v19, 16, v19
    v_mul_f32 v19, v29, v19
    v_cvt_pk_bf16_f32 v19, v19, v19
    v_lshlrev_b32 v19, 16, v19
    s_waitcnt vmcnt(8)
    v_lshlrev_b32 v104, 16, v52
    v_and_b32 v105, 0xffff0000, v52
    v_lshlrev_b32 v106, 16, v53
    v_and_b32 v107, 0xffff0000, v53
    v_lshlrev_b32 v108, 16, v54
    v_and_b32 v109, 0xffff0000, v54
    v_lshlrev_b32 v110, 16, v55
    v_and_b32 v111, 0xffff0000, v55
    v_fmac_f32 v112, v19, v104
    v_fmac_f32 v113, v19, v105
    v_fmac_f32 v114, v19, v106
    v_fmac_f32 v115, v19, v107
    v_fmac_f32 v116, v19, v108
    v_fmac_f32 v117, v19, v109
    v_fmac_f32 v118, v19, v110
    v_fmac_f32 v119, v19, v111
    v_lshlrev_b32 v104, 16, v72
    v_and_b32 v105, 0xffff0000, v72
    v_lshlrev_b32 v106, 16, v73
    v_and_b32 v107, 0xffff0000, v73
    v_lshlrev_b32 v108, 16, v74
    v_and_b32 v109, 0xffff0000, v74
    v_lshlrev_b32 v110, 16, v75
    v_and_b32 v111, 0xffff0000, v75
    v_fmac_f32 v120, v19, v104
    v_fmac_f32 v121, v19, v105
    v_fmac_f32 v122, v19, v106
    v_fmac_f32 v123, v19, v107
    v_fmac_f32 v124, v19, v108
    v_fmac_f32 v125, v19, v109
    v_fmac_f32 v126, v19, v110
    v_fmac_f32 v127, v19, v111
    v_lshlrev_b32 v20, 16, v20
    v_sub_f32 v20, v20, v28
    v_cvt_pk_bf16_f32 v20, v20, v20
    v_lshlrev_b32 v20, 16, v20
    v_mul_f32 v20, v29, v20
    v_cvt_pk_bf16_f32 v20, v20, v20
    v_lshlrev_b32 v20, 16, v20
    s_waitcnt vmcnt(6)
    v_lshlrev_b32 v104, 16, v56
    v_and_b32 v105, 0xffff0000, v56
    v_lshlrev_b32 v106, 16, v57
    v_and_b32 v107, 0xffff0000, v57
    v_lshlrev_b32 v108, 16, v58
    v_and_b32 v109, 0xffff0000, v58
    v_lshlrev_b32 v110, 16, v59
    v_and_b32 v111, 0xffff0000, v59
    v_fmac_f32 v112, v20, v104
    v_fmac_f32 v113, v20, v105
    v_fmac_f32 v114, v20, v106
    v_fmac_f32 v115, v20, v107
    v_fmac_f32 v116, v20, v108
    v_fmac_f32 v117, v20, v109
    v_fmac_f32 v118, v20, v110
    v_fmac_f32 v119, v20, v111
    v_lshlrev_b32 v104, 16, v76
    v_and_b32 v105, 0xffff0000, v76
    v_lshlrev_b32 v106, 16, v77
    v_and_b32 v107, 0xffff0000, v77
    v_lshlrev_b32 v108, 16, v78
    v_and_b32 v109, 0xffff0000, v78
    v_lshlrev_b32 v110, 16, v79
    v_and_b32 v111, 0xffff0000, v79
    v_fmac_f32 v120, v20, v104
    v_fmac_f32 v121, v20, v105
    v_fmac_f32 v122, v20, v106
    v_fmac_f32 v123, v20, v107
    v_fmac_f32 v124, v20, v108
    v_fmac_f32 v125, v20, v109
    v_fmac_f32 v126, v20, v110
    v_fmac_f32 v127, v20, v111
    s_nop 1
    v_permlane32_swap_b32 v112, v120
    v_permlane32_swap_b32 v113, v121
    v_permlane32_swap_b32 v114, v122
    v_permlane32_swap_b32 v115, v123
    v_permlane32_swap_b32 v116, v124
    v_permlane32_swap_b32 v117, v125
    v_permlane32_swap_b32 v118, v126
    v_permlane32_swap_b32 v119, v127
    s_nop 1
    v_add_f32 v112, v112, v120
    v_add_f32 v113, v113, v121
    v_add_f32 v114, v114, v122
    v_add_f32 v115, v115, v123
    v_add_f32 v116, v116, v124
    v_add_f32 v117, v117, v125
    v_add_f32 v118, v118, v126
    v_add_f32 v119, v119, v127
    s_nop 1
    v_permlane16_swap_b32 v112, v116
    v_permlane16_swap_b32 v113, v117
    v_permlane16_swap_b32 v114, v118
    v_permlane16_swap_b32 v115, v119
    s_nop 1
    v_add_f32 v112, v112, v116
    v_add_f32 v113, v113, v117
    v_add_f32 v114, v114, v118
    v_add_f32 v115, v115, v119
    s_nop 1
    v_add_f32_dpp v116, v112, v112 row_ror:8 row_mask:0xf bank_mask:0xf
    v_add_f32_dpp v117, v113, v113 row_ror:8 row_mask:0xf bank_mask:0xf
    v_add_f32_dpp v118, v114, v114 row_ror:8 row_mask:0xf bank_mask:0xf
    v_add_f32_dpp v119, v115, v115 row_ror:8 row_mask:0xf bank_mask:0xf
    v_mov_b32 v112, v116
    v_mov_b32 v113, v117
    v_mov_b32 v114, v118
    v_mov_b32 v115, v119
    s_nop 1
    v_add_f32_dpp v116, v112, v112 row_ror:4 row_mask:0xf bank_mask:0xf
    v_add_f32_dpp v117, v113, v113 row_ror:4 row_mask:0xf bank_mask:0xf
    v_add_f32_dpp v118, v114, v114 row_ror:4 row_mask:0xf bank_mask:0xf
    v_add_f32_dpp v119, v115, v115 row_ror:4 row_mask:0xf bank_mask:0xf
    v_mov_b32 v112, v116
    v_mov_b32 v113, v117
    v_mov_b32 v114, v118
    v_mov_b32 v115, v119
    v_lshrrev_b32 v104, 5, v1
    v_lshlrev_b32 v104, 7, v104
    v_bfe_u32 v105, v1, 4, 1
    v_lshl_add_u32 v104, v105, 4, v104
    v_lshl_add_u32 v104, v9, 5, v104
    s_lshl_b32 s35, s3, 8
    v_add_u32 v104, s35, v104
    ds_write_b128 v104, v[112:115] offset:64
    s_waitcnt lgkmcnt(0)
    s_barrier
    v_lshlrev_b32 v104, 2, v1
    ds_read_b32 v112, v104 offset:64
    ds_read_b32 v113, v104 offset:320
    ds_read_b32 v114, v104 offset:576
    ds_read_b32 v115, v104 offset:832
    ds_read_b32 v116, v104 offset:1088
    ds_read_b32 v117, v104 offset:1344
    ds_read_b32 v118, v104 offset:1600
    ds_read_b32 v119, v104 offset:1856
    s_waitcnt lgkmcnt(0)
    v_add_f32 v112, v112, v113
    v_add_f32 v114, v114, v115
    v_add_f32 v116, v116, v117
    v_add_f32 v118, v118, v119
    v_add_f32 v112, v112, v114
    v_add_f32 v116, v116, v118
    v_add_f32 v112, v112, v116
    v_cvt_pk_bf16_f32 v112, v112, v112
    v_lshlrev_b32 v112, 16, v112
    v_mov_b32 v113, v112
    s_nop 1
    v_permlane32_swap_b32 v112, v113
    s_nop 1
    v_mul_f32 v114, 0xbfb8aa3b, v112
    v_exp_f32 v114, v114
    s_nop 0
    v_add_f32 v114, 1.0, v114
    v_rcp_f32 v114, v114
    s_nop 0
    v_mul_f32 v112, v112, v114
    v_cvt_pk_bf16_f32 v112, v112, v112
    v_lshlrev_b32 v112, 16, v112
    v_mul_f32 v112, v112, v113
    v_cvt_pk_bf16_f32 v112, v112, v112
    v_lshlrev_b32 v112, 16, v112
    v_lshlrev_b32 v104, 2, v5
    v_add_u32 v105, 0, v104
    v_add_u32 v106, 24, v104
    v_add_u32 v107, 48, v104
    v_add_u32 v108, 72, v104
    v_add_u32 v109, 96, v104
    v_add_u32 v110, 120, v104
    ds_bpermute_b32 v16, v105, v112
    ds_bpermute_b32 v17, v106, v112
    ds_bpermute_b32 v18, v107, v112
    ds_bpermute_b32 v19, v108, v112
    ds_bpermute_b32 v20, v109, v112
    ds_bpermute_b32 v21, v110, v112
    v_cmp_gt_u32 vcc, 2, v5
    v_mov_b32 v116, 0
    v_mov_b32 v117, 0
    v_mov_b32 v118, 0
    v_mov_b32 v119, 0
    v_mov_b32 v120, 0
    v_mov_b32 v121, 0
    v_mov_b32 v122, 0
    v_mov_b32 v123, 0
    s_waitcnt vmcnt(0) lgkmcnt(0)
    v_cndmask_b32 v21, 0, v21, vcc
    v_lshlrev_b32 v104, 16, v80
    v_and_b32 v105, 0xffff0000, v80
    v_lshlrev_b32 v106, 16, v81
    v_and_b32 v107, 0xffff0000, v81
    v_lshlrev_b32 v108, 16, v82
    v_and_b32 v109, 0xffff0000, v82
    v_lshlrev_b32 v110, 16, v83
    v_and_b32 v111, 0xffff0000, v83
    v_fmac_f32 v116, v16, v104
    v_fmac_f32 v117, v16, v105
    v_fmac_f32 v118, v16, v106
    v_fmac_f32 v119, v16, v107
    v_fmac_f32 v120, v16, v108
    v_fmac_f32 v121, v16, v109
    v_fmac_f32 v122, v16, v110
    v_fmac_f32 v123, v16, v111
    v_lshlrev_b32 v104, 16, v84
    v_and_b32 v105, 0xffff0000, v84
    v_lshlrev_b32 v106, 16, v85
    v_and_b32 v107, 0xffff0000, v85
    v_lshlrev_b32 v108, 16, v86
    v_and_b32 v109, 0xffff0000, v86
    v_lshlrev_b32 v110, 16, v87
    v_and_b32 v111, 0xffff0000, v87
    v_fmac_f32 v116, v17, v104
    v_fmac_f32 v117, v17, v105
    v_fmac_f32 v118, v17, v106
    v_fmac_f32 v119, v17, v107
    v_fmac_f32 v120, v17, v108
    v_fmac_f32 v121, v17, v109
    v_fmac_f32 v122, v17, v110
    v_fmac_f32 v123, v17, v111
    v_lshlrev_b32 v104, 16, v88
    v_and_b32 v105, 0xffff0000, v88
    v_lshlrev_b32 v106, 16, v89
    v_and_b32 v107, 0xffff0000, v89
    v_lshlrev_b32 v108, 16, v90
    v_and_b32 v109, 0xffff0000, v90
    v_lshlrev_b32 v110, 16, v91
    v_and_b32 v111, 0xffff0000, v91
    v_fmac_f32 v116, v18, v104
    v_fmac_f32 v117, v18, v105
    v_fmac_f32 v118, v18, v106
    v_fmac_f32 v119, v18, v107
    v_fmac_f32 v120, v18, v108
    v_fmac_f32 v121, v18, v109
    v_fmac_f32 v122, v18, v110
    v_fmac_f32 v123, v18, v111
    v_lshlrev_b32 v104, 16, v92
    v_and_b32 v105, 0xffff0000, v92
    v_lshlrev_b32 v106, 16, v93
    v_and_b32 v107, 0xffff0000, v93
    v_lshlrev_b32 v108, 16, v94
    v_and_b32 v109, 0xffff0000, v94
    v_lshlrev_b32 v110, 16, v95
    v_and_b32 v111, 0xffff0000, v95
    v_fmac_f32 v116, v19, v104
    v_fmac_f32 v117, v19, v105
    v_fmac_f32 v118, v19, v106
    v_fmac_f32 v119, v19, v107
    v_fmac_f32 v120, v19, v108
    v_fmac_f32 v121, v19, v109
    v_fmac_f32 v122, v19, v110
    v_fmac_f32 v123, v19, v111
    v_lshlrev_b32 v104, 16, v96
    v_and_b32 v105, 0xffff0000, v96
    v_lshlrev_b32 v106, 16, v97
    v_and_b32 v107, 0xffff0000, v97
    v_lshlrev_b32 v108, 16, v98
    v_and_b32 v109, 0xffff0000, v98
    v_lshlrev_b32 v110, 16, v99
    v_and_b32 v111, 0xffff0000, v99
    v_fmac_f32 v116, v20, v104
    v_fmac_f32 v117, v20, v105
    v_fmac_f32 v118, v20, v106
    v_fmac_f32 v119, v20, v107
    v_fmac_f32 v120, v20, v108
    v_fmac_f32 v121, v20, v109
    v_fmac_f32 v122, v20, v110
    v_fmac_f32 v123, v20, v111
    v_lshlrev_b32 v104, 16, v100
    v_and_b32 v105, 0xffff0000, v100
    v_lshlrev_b32 v106, 16, v101
    v_and_b32 v107, 0xffff0000, v101
    v_lshlrev_b32 v108, 16, v102
    v_and_b32 v109, 0xffff0000, v102
    v_lshlrev_b32 v110, 16, v103
    v_and_b32 v111, 0xffff0000, v103
    v_fmac_f32 v116, v21, v104
    v_fmac_f32 v117, v21, v105
    v_fmac_f32 v118, v21, v106
    v_fmac_f32 v119, v21, v107
    v_fmac_f32 v120, v21, v108
    v_fmac_f32 v121, v21, v109
    v_fmac_f32 v122, v21, v110
    v_fmac_f32 v123, v21, v111
    v_mul_u32_u24 v104, 2560, v5
    v_lshl_add_u32 v104, v6, 5, v104
    ds_write_b128 v104, v[116:119] offset:4096
    ds_write_b128 v104, v[120:123] offset:4112
    s_waitcnt lgkmcnt(0)
    s_barrier
    v_lshlrev_b32 v104, 2, v0
    ds_read_b32 v112, v104 offset:4096
    ds_read_b32 v113, v104 offset:6656
    ds_read_b32 v114, v104 offset:9216
    ds_read_b32 v115, v104 offset:11776
    ds_read_b32 v116, v104 offset:14336
    ds_read_b32 v117, v104 offset:16896
    s_cmp_ge_u32 s3, 2
    s_cbranch_scc1 k4_kernel_na_2
    ds_read_b32 v120, v104 offset:6144
    ds_read_b32 v121, v104 offset:8704
    ds_read_b32 v122, v104 offset:11264
    ds_read_b32 v123, v104 offset:13824
    ds_read_b32 v124, v104 offset:16384
    ds_read_b32 v125, v104 offset:18944
    s_waitcnt lgkmcnt(0)
    v_add_f32 v120, v120, v121
    v_add_f32 v122, v122, v123
    v_add_f32 v124, v124, v125
    v_add_f32 v120, v120, v122
    v_add_f32 v120, v120, v124
    v_add_u32 v105, 0x811000, v104
    buffer_atomic_add_f32 v120, v105, s[8:11], 0 offen offset:2048
k4_kernel_na_2:
    s_waitcnt lgkmcnt(0)
    v_add_f32 v112, v112, v113
    v_add_f32 v114, v114, v115
    v_add_f32 v116, v116, v117
    v_add_f32 v112, v112, v114
    v_add_f32 v112, v112, v116
    v_add_u32 v105, 0x811000, v104
    buffer_atomic_add_f32 v112, v105, s[8:11], 0 offen
    s_waitcnt vmcnt(0)
    s_barrier
    s_cmp_lg_u32 s3, 0
    s_cbranch_scc1 k4_kernel_end
    v_mov_b32 v104, 1
    v_mov_b32 v105, 0
    s_mov_b64 exec, 1
    buffer_atomic_add v104, v105, s[56:59], 0 offen sc0 sc1
    s_mov_b64 exec, -1
    v_lshlrev_b32 v108, 2, v1
    v_add_u32 v108, s37, v108
    v_add_u32 v109, 0x580000, v108
    buffer_load_dword v60, v109, s[8:11], 0 offen offset:0
    buffer_load_dword v61, v109, s[8:11], 0 offen offset:256
    buffer_load_dword v62, v109, s[8:11], 0 offen offset:512
    buffer_load_dword v63, v109, s[8:11], 0 offen offset:768
    buffer_load_dword v64, v109, s[8:11], 0 offen offset:1024
    v_cvt_pk_bf16_f32 v13, v13, v13
    v_lshlrev_b32 v13, 16, v13
    v_mul_f32 v13, 0xbfb8aa3b, v13
    v_exp_f32 v13, v13
    s_nop 0
    v_add_f32 v13, 1.0, v13
    v_rcp_f32 v13, v13
    s_nop 0
    v_cvt_pk_bf16_f32 v13, v13, v13
    v_lshlrev_b32 v13, 16, v13
    s_waitcnt vmcnt(5)
    v_readfirstlane_b32 s35, v104
    s_nop 3
    s_cmp_lg_u32 s35, 53
    s_cbranch_scc1 k4_kernel_end
    buffer_inv sc1
    s_waitcnt vmcnt(0)
    v_lshlrev_b32 v104, 3, v1
    v_add_u32 v104, 0x811000, v104
    buffer_load_dwordx2 v[40:41], v104, s[8:11], 0 offen offset:0 sc0 sc1
    buffer_load_dwordx2 v[42:43], v104, s[8:11], 0 offen offset:512 sc0 sc1
    buffer_load_dwordx2 v[44:45], v104, s[8:11], 0 offen offset:1024 sc0 sc1
    buffer_load_dwordx2 v[46:47], v104, s[8:11], 0 offen offset:1536 sc0 sc1
    buffer_load_dwordx2 v[48:49], v104, s[8:11], 0 offen offset:2048 sc0 sc1
    s_waitcnt vmcnt(0)
    v_lshlrev_b32 v110, 16, v60
    v_and_b32 v111, 0xffff0000, v60
    v_cvt_pk_bf16_f32 v40, v40, v40
    v_lshlrev_b32 v40, 16, v40
    v_mul_f32 v40, v13, v40
    v_cvt_pk_bf16_f32 v40, v40, v40
    v_lshlrev_b32 v40, 16, v40
    v_sub_f32 v112, v110, v28
    v_cvt_pk_bf16_f32 v112, v112, v112
    v_lshlrev_b32 v112, 16, v112
    v_mul_f32 v112, v29, v112
    v_cvt_pk_bf16_f32 v112, v112, v112
    v_lshlrev_b32 v112, 16, v112
    v_add_f32 v112, v112, v40
    v_cvt_pk_bf16_f32 v112, v112, v112
    v_lshlrev_b32 v112, 16, v112
    v_add_f32 v40, v110, v112
    v_cvt_pk_bf16_f32 v41, v41, v41
    v_lshlrev_b32 v41, 16, v41
    v_mul_f32 v41, v13, v41
    v_cvt_pk_bf16_f32 v41, v41, v41
    v_lshlrev_b32 v41, 16, v41
    v_sub_f32 v112, v111, v28
    v_cvt_pk_bf16_f32 v112, v112, v112
    v_lshlrev_b32 v112, 16, v112
    v_mul_f32 v112, v29, v112
    v_cvt_pk_bf16_f32 v112, v112, v112
    v_lshlrev_b32 v112, 16, v112
    v_add_f32 v112, v112, v41
    v_cvt_pk_bf16_f32 v112, v112, v112
    v_lshlrev_b32 v112, 16, v112
    v_add_f32 v41, v111, v112
    v_cvt_pk_bf16_f32 v70, v40, v41
    buffer_store_dword v70, v108, s[12:15], 0 offen offset:0
    v_lshlrev_b32 v110, 16, v61
    v_and_b32 v111, 0xffff0000, v61
    v_cvt_pk_bf16_f32 v42, v42, v42
    v_lshlrev_b32 v42, 16, v42
    v_mul_f32 v42, v13, v42
    v_cvt_pk_bf16_f32 v42, v42, v42
    v_lshlrev_b32 v42, 16, v42
    v_sub_f32 v112, v110, v28
    v_cvt_pk_bf16_f32 v112, v112, v112
    v_lshlrev_b32 v112, 16, v112
    v_mul_f32 v112, v29, v112
    v_cvt_pk_bf16_f32 v112, v112, v112
    v_lshlrev_b32 v112, 16, v112
    v_add_f32 v112, v112, v42
    v_cvt_pk_bf16_f32 v112, v112, v112
    v_lshlrev_b32 v112, 16, v112
    v_add_f32 v42, v110, v112
    v_cvt_pk_bf16_f32 v43, v43, v43
    v_lshlrev_b32 v43, 16, v43
    v_mul_f32 v43, v13, v43
    v_cvt_pk_bf16_f32 v43, v43, v43
    v_lshlrev_b32 v43, 16, v43
    v_sub_f32 v112, v111, v28
    v_cvt_pk_bf16_f32 v112, v112, v112
    v_lshlrev_b32 v112, 16, v112
    v_mul_f32 v112, v29, v112
    v_cvt_pk_bf16_f32 v112, v112, v112
    v_lshlrev_b32 v112, 16, v112
    v_add_f32 v112, v112, v43
    v_cvt_pk_bf16_f32 v112, v112, v112
    v_lshlrev_b32 v112, 16, v112
    v_add_f32 v43, v111, v112
    v_cvt_pk_bf16_f32 v71, v42, v43
    buffer_store_dword v71, v108, s[12:15], 0 offen offset:256
    v_lshlrev_b32 v110, 16, v62
    v_and_b32 v111, 0xffff0000, v62
    v_cvt_pk_bf16_f32 v44, v44, v44
    v_lshlrev_b32 v44, 16, v44
    v_mul_f32 v44, v13, v44
    v_cvt_pk_bf16_f32 v44, v44, v44
    v_lshlrev_b32 v44, 16, v44
    v_sub_f32 v112, v110, v28
    v_cvt_pk_bf16_f32 v112, v112, v112
    v_lshlrev_b32 v112, 16, v112
    v_mul_f32 v112, v29, v112
    v_cvt_pk_bf16_f32 v112, v112, v112
    v_lshlrev_b32 v112, 16, v112
    v_add_f32 v112, v112, v44
    v_cvt_pk_bf16_f32 v112, v112, v112
    v_lshlrev_b32 v112, 16, v112
    v_add_f32 v44, v110, v112
    v_cvt_pk_bf16_f32 v45, v45, v45
    v_lshlrev_b32 v45, 16, v45
    v_mul_f32 v45, v13, v45
    v_cvt_pk_bf16_f32 v45, v45, v45
    v_lshlrev_b32 v45, 16, v45
    v_sub_f32 v112, v111, v28
    v_cvt_pk_bf16_f32 v112, v112, v112
    v_lshlrev_b32 v112, 16, v112
    v_mul_f32 v112, v29, v112
    v_cvt_pk_bf16_f32 v112, v112, v112
    v_lshlrev_b32 v112, 16, v112
    v_add_f32 v112, v112, v45
    v_cvt_pk_bf16_f32 v112, v112, v112
    v_lshlrev_b32 v112, 16, v112
    v_add_f32 v45, v111, v112
    v_cvt_pk_bf16_f32 v72, v44, v45
    buffer_store_dword v72, v108, s[12:15], 0 offen offset:512
    v_lshlrev_b32 v110, 16, v63
    v_and_b32 v111, 0xffff0000, v63
    v_cvt_pk_bf16_f32 v46, v46, v46
    v_lshlrev_b32 v46, 16, v46
    v_mul_f32 v46, v13, v46
    v_cvt_pk_bf16_f32 v46, v46, v46
    v_lshlrev_b32 v46, 16, v46
    v_sub_f32 v112, v110, v28
    v_cvt_pk_bf16_f32 v112, v112, v112
    v_lshlrev_b32 v112, 16, v112
    v_mul_f32 v112, v29, v112
    v_cvt_pk_bf16_f32 v112, v112, v112
    v_lshlrev_b32 v112, 16, v112
    v_add_f32 v112, v112, v46
    v_cvt_pk_bf16_f32 v112, v112, v112
    v_lshlrev_b32 v112, 16, v112
    v_add_f32 v46, v110, v112
    v_cvt_pk_bf16_f32 v47, v47, v47
    v_lshlrev_b32 v47, 16, v47
    v_mul_f32 v47, v13, v47
    v_cvt_pk_bf16_f32 v47, v47, v47
    v_lshlrev_b32 v47, 16, v47
    v_sub_f32 v112, v111, v28
    v_cvt_pk_bf16_f32 v112, v112, v112
    v_lshlrev_b32 v112, 16, v112
    v_mul_f32 v112, v29, v112
    v_cvt_pk_bf16_f32 v112, v112, v112
    v_lshlrev_b32 v112, 16, v112
    v_add_f32 v112, v112, v47
    v_cvt_pk_bf16_f32 v112, v112, v112
    v_lshlrev_b32 v112, 16, v112
    v_add_f32 v47, v111, v112
    v_cvt_pk_bf16_f32 v73, v46, v47
    buffer_store_dword v73, v108, s[12:15], 0 offen offset:768
    v_lshlrev_b32 v110, 16, v64
    v_and_b32 v111, 0xffff0000, v64
    v_cvt_pk_bf16_f32 v48, v48, v48
    v_lshlrev_b32 v48, 16, v48
    v_mul_f32 v48, v13, v48
    v_cvt_pk_bf16_f32 v48, v48, v48
    v_lshlrev_b32 v48, 16, v48
    v_sub_f32 v112, v110, v28
    v_cvt_pk_bf16_f32 v112, v112, v112
    v_lshlrev_b32 v112, 16, v112
    v_mul_f32 v112, v29, v112
    v_cvt_pk_bf16_f32 v112, v112, v112
    v_lshlrev_b32 v112, 16, v112
    v_add_f32 v112, v112, v48
    v_cvt_pk_bf16_f32 v112, v112, v112
    v_lshlrev_b32 v112, 16, v112
    v_add_f32 v48, v110, v112
    v_cvt_pk_bf16_f32 v49, v49, v49
    v_lshlrev_b32 v49, 16, v49
    v_mul_f32 v49, v13, v49
    v_cvt_pk_bf16_f32 v49, v49, v49
    v_lshlrev_b32 v49, 16, v49
    v_sub_f32 v112, v111, v28
    v_cvt_pk_bf16_f32 v112, v112, v112
    v_lshlrev_b32 v112, 16, v112
    v_mul_f32 v112, v29, v112
    v_cvt_pk_bf16_f32 v112, v112, v112
    v_lshlrev_b32 v112, 16, v112
    v_add_f32 v112, v112, v49
    v_cvt_pk_bf16_f32 v112, v112, v112
    v_lshlrev_b32 v112, 16, v112
    v_add_f32 v49, v111, v112
    v_cvt_pk_bf16_f32 v74, v48, v49
    buffer_store_dword v74, v108, s[12:15], 0 offen offset:1024
k4_kernel_end:
k4_kernel_exit:
    s_endpgm
.section .rodata,"a"
.p2align 6
.amdhsa_kernel k4_kernel
  .amdhsa_next_free_vgpr 128
  .amdhsa_next_free_sgpr 64
  .amdhsa_accum_offset 128
  .amdhsa_group_segment_fixed_size 0
  .amdhsa_kernarg_size 104
  .amdhsa_user_sgpr_count 2
  .amdhsa_user_sgpr_kernarg_segment_ptr 1
  .amdhsa_system_sgpr_workgroup_id_x 1
.end_amdhsa_kernel
```
